```python
import torch

def _softmax(x, axis=-1):
    return torch.softmax(x, dim=axis)
def _gelu(x):
    return torch.nn.functional.gelu(x, approximate="tanh")
def _silu(x):
    return torch.nn.functional.silu(x)
def _sigmoid(x):
    return torch.sigmoid(x)
def _layernorm(x, axis=-1, eps=1e-5):
    m = x.mean(dim=axis, keepdim=True)
    v = x.var(dim=axis, keepdim=True, unbiased=False)
    return (x - m) / torch.sqrt(v + eps)
def _scatter_add(tgt, idx, src, axis=0):
    return tgt.clone().index_add_(axis, idx, src)
def _segment_sum(src, seg, n):
    out = torch.zeros((n,) + src.shape[1:], dtype=src.dtype)
    return out.index_add_(0, seg, src)
def _pad(x, pw):
    flat = tuple(v for pair in reversed(pw) for v in pair)
    return torch.nn.functional.pad(x, flat)

kernel_name = 'recurrent_scan__gqa_block_cached__swiglu_ffn__decode'

def setup_inputs():

    _w = (lambda a: (lambda t: t.to(torch.bfloat16) if t.is_floating_point() else t)(torch.as_tensor(a)))
    def _A_setup():
        B, Sq, D = 8, 1, 448
        Hq, Hkv, Sk, Dh = 16, 8, 4096, 256
        assert Hq % Hkv == 0, (Hq, Hkv)
        return {
            "x": _w((lambda *s: torch.randn(*s, dtype=torch.bfloat16) * 0.05)(B, Sq, D)),
            "k_cache": _w((lambda *s: torch.randn(*s, dtype=torch.bfloat16) * 1.6)(B, Hkv, Sk, Dh)),
            "v_cache": _w((lambda *s: torch.randn(*s, dtype=torch.bfloat16) * 0.2)(B, Hkv, Sk, Dh)),
            "wq": _w((lambda *s: torch.randn(*s, dtype=torch.bfloat16) * 1.6)(D, Hq * Dh) * (D ** -0.5)),
            "wo": _w((lambda *s: torch.randn(*s, dtype=torch.bfloat16) * 0.2)(Hq * Dh, D) * ((Hq * Dh) ** -0.5)),
        }
    _A_in = _A_setup()

    def _B_setup():
        B, S, D, F = 8, 1, 448, 1792
        return {
            "x": _w((lambda *s: torch.randn(*s, dtype=torch.bfloat16) * 0.05)(B, S, D)),
            "w_gate": _w((lambda *s: torch.randn(*s, dtype=torch.bfloat16) * 0.1)(D, F)),
            "w_up": _w((lambda *s: torch.randn(*s, dtype=torch.bfloat16) * 0.1)(D, F)),
            "w_down": _w((lambda *s: torch.randn(*s, dtype=torch.bfloat16) * 0.1)(F, D)),
        }
    _B_in = _B_setup()

    return {
        "A_x": _A_in["x"],
        "A_k_cache": _A_in["k_cache"],
        "A_v_cache": _A_in["v_cache"],
        "A_wq": _A_in["wq"],
        "A_wo": _A_in["wo"],
        "B_x": _B_in["x"],
        "B_w_gate": _B_in["w_gate"],
        "B_w_up": _B_in["w_up"],
        "B_w_down": _B_in["w_down"],
    }

def reference(A_x, A_k_cache, A_v_cache, A_wq, A_wo, B_x, B_w_gate, B_w_up, B_w_down):
    def _A_ref(x, k_cache, v_cache, wq, wo):
        B, Sq, D = x.shape
        Hq, Dh = 16, 256
        Hkv = k_cache.shape[1]
        rep = Hq // Hkv
        q = (lambda x, *d: x.permute(*d))((x @ wq).reshape(B, Sq, Hq, Dh), 0, 2, 1, 3)
        k = (lambda x, n, axis: torch.repeat_interleave(x, n, dim=axis))(k_cache, rep, axis=1)
        v = (lambda x, n, axis: torch.repeat_interleave(x, n, dim=axis))(v_cache, rep, axis=1)
        scores = torch.einsum("bhqd,bhkd->bhqk", q, k) * (Dh ** -0.5)
        p = _softmax(scores, axis=-1)
        o = torch.einsum("bhqk,bhkd->bhqd", p, v)
        return (lambda x, *d: x.permute(*d))(o, 0, 2, 1, 3).reshape(B, Sq, Hq * Dh) @ wo

    def _B_ref(x, w_gate, w_up, w_down):
        g = _silu(x @ w_gate)
        u = x @ w_up
        return (g * u) @ w_down

    x = A_x
    xn = _layernorm(x, axis=-1)
    s = _A_ref(xn, A_k_cache, A_v_cache, A_wq, A_wo)
    g = _silu(_B_ref(xn, B_w_gate, B_w_up, B_w_down))
    return x + s * g
```

```asm
; @launch grid=(256,1,1) block=(320,1,1) lds=163840
.amdgcn_target "amdgcn-amd-amdhsa--gfx950"
.text
.globl recurrent_scan__gqa_block_cached__swiglu_ffn__decode_kernel
.p2align 8
.type recurrent_scan__gqa_block_cached__swiglu_ffn__decode_kernel,@function
recurrent_scan__gqa_block_cached__swiglu_ffn__decode_kernel:
  s_cmp_ge_u32 s2, 0x100
  s_cbranch_scc1 L_end
  s_getpc_b64 s[54:55]
L_pc0:
  s_sub_u32 s54, s54, L_pc0-recurrent_scan__gqa_block_cached__swiglu_ffn__decode_kernel
  s_subb_u32 s55, s55, 0
  s_lshr_b32 s43, s2, 3
  s_and_b32 s43, s43, 3
  s_lshl_b32 s43, s43, 12
  v_lshl_add_u32 v252, v0, 4, s43
  v_min_u32 v252, L_codeend-recurrent_scan__gqa_block_cached__swiglu_ffn__decode_kernel-16, v252
  global_load_dwordx4 v[252:255], v252, s[54:55]
  s_load_dwordx4 s[4:7], s[0:1], 0
  s_load_dwordx4 s[8:11], s[0:1], 16
  s_load_dwordx2 s[24:25], s[0:1], 88
  s_load_dwordx2 s[12:13], s[0:1], 32
  s_load_dwordx4 s[16:19], s[0:1], 48
  s_load_dwordx4 s[20:23], s[0:1], 64
  s_load_dwordx2 s[14:15], s[0:1], 80
  s_mov_b32 s96, s2
  s_lshr_b32 s40, s2, 6
  s_add_u32 s42, s2, s40
  s_and_b32 s42, s42, 63
  s_lshl_b32 s2, s42, 2
  s_add_u32 s2, s2, s40
  v_lshrrev_b32 v1, 6, v0
  v_and_b32 v0, 63, v0
  s_lshr_b32 s26, s2, 5
  v_readfirstlane_b32 s3, v1
  s_lshr_b32 s42, s2, 2
  s_and_b32 s27, s42, 7
  s_and_b32 s40, s2, 3
  s_mov_b32 s48, 0x3db8aa3b
  s_and_b32 s94, s40, 1
  s_lshl_b32 s94, s94, 1
  s_lshr_b32 s43, s40, 1
  s_or_b32 s94, s94, s43
  s_mov_b32 s95, s42
  s_and_b32 s43, s94, 1
  s_cmp_eq_u32 s43, 0
  s_cselect_b32 s60, 1, 0
  s_cmp_eq_u32 s94, 2
  s_cselect_b32 s43, s95, 0
  s_cmp_ge_u32 s43, 56
  s_cselect_b32 s60, 0, s60
  s_waitcnt lgkmcnt(0)
  s_load_dword s41, s[24:25], 0
  s_cmp_eq_u32 s3, 4
  s_cbranch_scc1 L_service
  v_lshrrev_b32 v1, 5, v0
  v_and_b32 v2, 31, v0
  s_cmp_eq_u32 s60, 0
  s_cbranch_scc1 L_np0
  s_cmp_lg_u32 s94, 0
  s_cbranch_scc1 L_noinit
  s_and_b32 s43, s95, 7
  s_lshl_b32 s43, s43, 3
  s_lshr_b32 s47, s95, 3
  s_add_u32 s43, s43, s47
  s_lshl_b32 s43, s43, 2
  s_add_u32 s43, s43, s3
  s_lshl_b32 s43, s43, 7
  s_add_u32 s43, s43, 7340032
  v_mov_b32 v4, s43
  v_mov_b32 v5, 0
  s_mov_b64 exec, 1
  global_store_dword v4, v5, s[24:25] sc1
  s_mov_b64 exec, -1
L_noinit:
  s_lshl_b32 s43, s3, 1
  v_add_u32 v3, s43, v1
  v_mul_u32_u24 v4, 896, v3
  v_lshl_add_u32 v4, v2, 4, v4
  v_mov_b32 v224, 0
  v_mov_b32 v225, 0
  v_mov_b32 v226, 0
  v_mov_b32 v227, 0
  v_mov_b32 v228, 0
  v_mov_b32 v229, 0
  v_mov_b32 v230, 0
  v_mov_b32 v231, 0
  s_mov_b32 s52, 0x0fffffff
  s_mov_b32 s53, 0x0fffffff
  s_mov_b64 exec, s[52:53]
  global_load_dwordx4 v[224:227], v4, s[4:5]
  global_load_dwordx4 v[228:231], v4, s[4:5] offset:448
  s_mov_b64 exec, -1
  s_cmp_eq_u32 s94, 0
  s_cbranch_scc0 L_wffn
  s_mov_b32 s56, s10
  s_mov_b32 s57, s11
  s_mov_b32 s58, 3670016
  s_mov_b32 s59, 0x20000
  s_mov_b32 s61, 8192
  s_mov_b32 s62, s95
  s_mov_b32 s63, 0
  s_branch L_wset
L_wffn:
  s_mov_b32 s61, 3584
  s_lshr_b32 s62, s95, 1
  s_mov_b32 s58, 1605632
  s_mov_b32 s59, 0x20000
  s_and_b32 s43, s95, 1
  s_cmp_eq_u32 s43, 0
  s_cbranch_scc0 L_wup
  s_mov_b32 s56, s16
  s_mov_b32 s57, s17
  s_mov_b32 s63, 1
  s_branch L_wset
L_wup:
  s_mov_b32 s56, s18
  s_mov_b32 s57, s19
  s_mov_b32 s63, 2
L_wset:
  v_lshrrev_b32 v5, 3, v0
  v_mul_lo_u32 v5, s61, v5
  v_bfe_u32 v6, v0, 4, 1
  v_lshlrev_b32 v6, 1, v6
  v_and_b32 v7, 7, v0
  v_xor_b32 v6, v6, v7
  v_lshl_add_u32 v28, v6, 4, v5
  v_xor_b32 v29, 64, v28
  s_mul_i32 s47, s3, 112
  s_mul_i32 s47, s47, s61
  s_lshl_b32 s43, s62, 7
  s_add_u32 s47, s47, s43
  s_lshl_b32 s43, s61, 3
  s_lshl_b32 s44, s3, 15
  s_add_u32 s44, s44, 16384
  s_mov_b32 m0, s44
  s_nop 0
  buffer_load_dwordx4 v28, s[56:59], s47 offen nt lds
  s_add_u32 s47, s47, s43
  s_add_u32 m0, s44, 1024
  s_nop 0
  buffer_load_dwordx4 v29, s[56:59], s47 offen nt lds
  s_add_u32 s47, s47, s43
  s_add_u32 m0, s44, 2048
  s_nop 0
  buffer_load_dwordx4 v28, s[56:59], s47 offen nt lds
  s_add_u32 s47, s47, s43
  s_add_u32 m0, s44, 3072
  s_nop 0
  buffer_load_dwordx4 v29, s[56:59], s47 offen nt lds
  s_add_u32 s47, s47, s43
  s_add_u32 m0, s44, 4096
  s_nop 0
  buffer_load_dwordx4 v28, s[56:59], s47 offen nt lds
  s_add_u32 s47, s47, s43
  s_add_u32 m0, s44, 5120
  s_nop 0
  buffer_load_dwordx4 v29, s[56:59], s47 offen nt lds
  s_add_u32 s47, s47, s43
  s_add_u32 m0, s44, 6144
  s_nop 0
  buffer_load_dwordx4 v28, s[56:59], s47 offen nt lds
  s_add_u32 s47, s47, s43
  s_add_u32 m0, s44, 7168
  s_nop 0
  buffer_load_dwordx4 v29, s[56:59], s47 offen nt lds
  s_add_u32 s47, s47, s43
  s_add_u32 m0, s44, 8192
  s_nop 0
  buffer_load_dwordx4 v28, s[56:59], s47 offen nt lds
  s_add_u32 s47, s47, s43
  s_add_u32 m0, s44, 9216
  s_nop 0
  buffer_load_dwordx4 v29, s[56:59], s47 offen nt lds
  s_add_u32 s47, s47, s43
  s_add_u32 m0, s44, 10240
  s_nop 0
  buffer_load_dwordx4 v28, s[56:59], s47 offen nt lds
  s_add_u32 s47, s47, s43
  s_add_u32 m0, s44, 11264
  s_nop 0
  buffer_load_dwordx4 v29, s[56:59], s47 offen nt lds
  s_add_u32 s47, s47, s43
  s_add_u32 m0, s44, 12288
  s_nop 0
  buffer_load_dwordx4 v28, s[56:59], s47 offen nt lds
  s_add_u32 s47, s47, s43
  s_add_u32 m0, s44, 13312
  s_nop 0
  buffer_load_dwordx4 v29, s[56:59], s47 offen nt lds
L_np0:
  s_lshl_b32 s43, s42, 21
  s_add_u32 s28, s6, s43
  s_addc_u32 s29, s7, 0
  s_mov_b32 s30, 0x200000
  s_mov_b32 s31, 0x20000
  s_add_u32 s32, s8, s43
  s_addc_u32 s33, s9, 0
  s_mov_b32 s34, 0x200000
  s_mov_b32 s35, 0x20000
  s_mul_i32 s43, s3, 1024
  v_lshlrev_b32 v5, 9, v1
  v_add_u32 v5, s43, v5
  v_xor_b32 v6, v2, v1
  v_lshlrev_b32 v7, 1, v1
  v_xor_b32 v7, v2, v7
  v_xor_b32 v8, 0, v6
  v_lshl_add_u32 v12, v8, 4, v5
  v_xor_b32 v8, 0, v7
  v_lshl_add_u32 v20, v8, 4, v5
  v_xor_b32 v8, 2, v6
  v_lshl_add_u32 v13, v8, 4, v5
  v_add_u32 v13, 3072, v13
  v_xor_b32 v8, 4, v7
  v_lshl_add_u32 v21, v8, 4, v5
  v_add_u32 v21, 3072, v21
  v_xor_b32 v8, 4, v6
  v_lshl_add_u32 v14, v8, 4, v5
  v_add_u32 v14, 6144, v14
  v_xor_b32 v8, 8, v7
  v_lshl_add_u32 v22, v8, 4, v5
  v_add_u32 v22, 6144, v22
  v_xor_b32 v8, 6, v6
  v_lshl_add_u32 v15, v8, 4, v5
  v_add_u32 v15, 9216, v15
  v_xor_b32 v8, 12, v7
  v_lshl_add_u32 v23, v8, 4, v5
  v_add_u32 v23, 9216, v23
  v_xor_b32 v8, 8, v6
  v_lshl_add_u32 v16, v8, 4, v5
  v_add_u32 v16, 16384, v16
  v_xor_b32 v8, 0, v7
  v_lshl_add_u32 v24, v8, 4, v5
  v_add_u32 v24, 16384, v24
  v_xor_b32 v8, 10, v6
  v_lshl_add_u32 v17, v8, 4, v5
  v_add_u32 v17, 19456, v17
  v_xor_b32 v8, 4, v7
  v_lshl_add_u32 v25, v8, 4, v5
  v_add_u32 v25, 19456, v25
  v_xor_b32 v8, 12, v6
  v_lshl_add_u32 v18, v8, 4, v5
  v_add_u32 v18, 22528, v18
  v_xor_b32 v8, 8, v7
  v_lshl_add_u32 v26, v8, 4, v5
  v_add_u32 v26, 22528, v26
  v_xor_b32 v8, 14, v6
  v_lshl_add_u32 v19, v8, 4, v5
  v_add_u32 v19, 25600, v19
  v_xor_b32 v8, 12, v7
  v_lshl_add_u32 v27, v8, 4, v5
  v_add_u32 v27, 25600, v27
  s_mul_i32 s45, s40, 393216
  s_mov_b32 s49, 12
  s_lshl_b32 s44, s3, 15
  s_cmp_eq_u32 s60, 0
  s_cbranch_scc0 L_prod
  s_mov_b32 m0, s44
  s_nop 0
  buffer_load_dwordx4 v12, s[28:31], s45 offen offset:0 nt lds
  buffer_load_dwordx4 v13, s[28:31], s45 offen offset:1024 nt lds
  buffer_load_dwordx4 v14, s[28:31], s45 offen offset:2048 nt lds
  buffer_load_dwordx4 v15, s[28:31], s45 offen offset:3072 nt lds
  s_add_u32 m0, s44, 4096
  s_nop 0
  buffer_load_dwordx4 v16, s[28:31], s45 offen offset:0 nt lds
  buffer_load_dwordx4 v17, s[28:31], s45 offen offset:1024 nt lds
  buffer_load_dwordx4 v18, s[28:31], s45 offen offset:2048 nt lds
  buffer_load_dwordx4 v19, s[28:31], s45 offen offset:3072 nt lds
  s_add_u32 m0, s44, 8192
  s_nop 0
  buffer_load_dwordx4 v20, s[32:35], s45 offen offset:0 nt lds
  buffer_load_dwordx4 v21, s[32:35], s45 offen offset:1024 nt lds
  buffer_load_dwordx4 v22, s[32:35], s45 offen offset:2048 nt lds
  buffer_load_dwordx4 v23, s[32:35], s45 offen offset:3072 nt lds
  s_add_u32 m0, s44, 12288
  s_nop 0
  buffer_load_dwordx4 v24, s[32:35], s45 offen offset:0 nt lds
  buffer_load_dwordx4 v25, s[32:35], s45 offen offset:1024 nt lds
  buffer_load_dwordx4 v26, s[32:35], s45 offen offset:2048 nt lds
  buffer_load_dwordx4 v27, s[32:35], s45 offen offset:3072 nt lds
  s_add_u32 s45, s45, 32768
  s_waitcnt vmcnt(8)
  s_add_u32 m0, s44, 16384
  s_nop 0
  buffer_load_dwordx4 v12, s[28:31], s45 offen offset:0 nt lds
  buffer_load_dwordx4 v13, s[28:31], s45 offen offset:1024 nt lds
  buffer_load_dwordx4 v14, s[28:31], s45 offen offset:2048 nt lds
  buffer_load_dwordx4 v15, s[28:31], s45 offen offset:3072 nt lds
  s_add_u32 m0, s44, 20480
  s_nop 0
  buffer_load_dwordx4 v16, s[28:31], s45 offen offset:0 nt lds
  buffer_load_dwordx4 v17, s[28:31], s45 offen offset:1024 nt lds
  buffer_load_dwordx4 v18, s[28:31], s45 offen offset:2048 nt lds
  buffer_load_dwordx4 v19, s[28:31], s45 offen offset:3072 nt lds
  s_waitcnt vmcnt(8)
  s_add_u32 m0, s44, 24576
  s_nop 0
  buffer_load_dwordx4 v20, s[32:35], s45 offen offset:0 nt lds
  buffer_load_dwordx4 v21, s[32:35], s45 offen offset:1024 nt lds
  buffer_load_dwordx4 v22, s[32:35], s45 offen offset:2048 nt lds
  buffer_load_dwordx4 v23, s[32:35], s45 offen offset:3072 nt lds
  s_add_u32 m0, s44, 28672
  s_nop 0
  buffer_load_dwordx4 v24, s[32:35], s45 offen offset:0 nt lds
  buffer_load_dwordx4 v25, s[32:35], s45 offen offset:1024 nt lds
  buffer_load_dwordx4 v26, s[32:35], s45 offen offset:2048 nt lds
  buffer_load_dwordx4 v27, s[32:35], s45 offen offset:3072 nt lds
  s_add_u32 s45, s45, 32768
  s_waitcnt lgkmcnt(0)
  s_add_u32 s41, s41, 0x9e3779b9
  s_branch L_join
L_prod:
  s_waitcnt vmcnt(14) lgkmcnt(0)
  s_add_u32 s41, s41, 0x9e3779b9
  v_lshlrev_b32 v232, 16, v224
  v_and_b32 v233, 0xffff0000, v224
  v_lshlrev_b32 v234, 16, v225
  v_and_b32 v235, 0xffff0000, v225
  v_lshlrev_b32 v236, 16, v226
  v_and_b32 v237, 0xffff0000, v226
  v_lshlrev_b32 v238, 16, v227
  v_and_b32 v239, 0xffff0000, v227
  v_lshlrev_b32 v240, 16, v228
  v_and_b32 v241, 0xffff0000, v228
  v_lshlrev_b32 v242, 16, v229
  v_and_b32 v243, 0xffff0000, v229
  v_lshlrev_b32 v244, 16, v230
  v_and_b32 v245, 0xffff0000, v230
  v_lshlrev_b32 v246, 16, v231
  v_and_b32 v247, 0xffff0000, v231
  v_add_f32 v8, v232, v233
  v_add_f32 v9, v234, v235
  v_add_f32 v8, v8, v236
  v_add_f32 v9, v9, v237
  v_add_f32 v8, v8, v238
  v_add_f32 v9, v9, v239
  v_add_f32 v8, v8, v240
  v_add_f32 v9, v9, v241
  v_add_f32 v8, v8, v242
  v_add_f32 v9, v9, v243
  v_add_f32 v8, v8, v244
  v_add_f32 v9, v9, v245
  v_add_f32 v8, v8, v246
  v_add_f32 v9, v9, v247
  v_add_f32 v8, v8, v9
  s_nop 1
  v_add_f32_dpp v8, v8, v8 row_ror:8 row_mask:0xf bank_mask:0xf
  s_nop 1
  v_add_f32_dpp v8, v8, v8 row_ror:4 row_mask:0xf bank_mask:0xf
  s_nop 1
  v_add_f32_dpp v8, v8, v8 row_ror:2 row_mask:0xf bank_mask:0xf
  s_nop 1
  v_add_f32_dpp v8, v8, v8 row_ror:1 row_mask:0xf bank_mask:0xf
  v_mov_b32 v9, v8
  s_nop 1
  v_permlane16_swap_b32 v8, v9
  s_nop 0
  v_add_f32 v8, v8, v9
  v_mul_f32 v8, 0x3b124925, v8
  v_mov_b32 v9, 0
  v_mov_b32 v10, 0
  s_mov_b64 exec, s[52:53]
  v_sub_f32 v54, v232, v8
  v_sub_f32 v55, v233, v8
  v_fmac_f32 v9, v54, v54
  v_fmac_f32 v10, v55, v55
  v_sub_f32 v54, v234, v8
  v_sub_f32 v55, v235, v8
  v_fmac_f32 v9, v54, v54
  v_fmac_f32 v10, v55, v55
  v_sub_f32 v54, v236, v8
  v_sub_f32 v55, v237, v8
  v_fmac_f32 v9, v54, v54
  v_fmac_f32 v10, v55, v55
  v_sub_f32 v54, v238, v8
  v_sub_f32 v55, v239, v8
  v_fmac_f32 v9, v54, v54
  v_fmac_f32 v10, v55, v55
  v_sub_f32 v54, v240, v8
  v_sub_f32 v55, v241, v8
  v_fmac_f32 v9, v54, v54
  v_fmac_f32 v10, v55, v55
  v_sub_f32 v54, v242, v8
  v_sub_f32 v55, v243, v8
  v_fmac_f32 v9, v54, v54
  v_fmac_f32 v10, v55, v55
  v_sub_f32 v54, v244, v8
  v_sub_f32 v55, v245, v8
  v_fmac_f32 v9, v54, v54
  v_fmac_f32 v10, v55, v55
  v_sub_f32 v54, v246, v8
  v_sub_f32 v55, v247, v8
  v_fmac_f32 v9, v54, v54
  v_fmac_f32 v10, v55, v55
  s_mov_b64 exec, -1
  v_add_f32 v9, v9, v10
  s_nop 1
  v_add_f32_dpp v9, v9, v9 row_ror:8 row_mask:0xf bank_mask:0xf
  s_nop 1
  v_add_f32_dpp v9, v9, v9 row_ror:4 row_mask:0xf bank_mask:0xf
  s_nop 1
  v_add_f32_dpp v9, v9, v9 row_ror:2 row_mask:0xf bank_mask:0xf
  s_nop 1
  v_add_f32_dpp v9, v9, v9 row_ror:1 row_mask:0xf bank_mask:0xf
  v_mov_b32 v10, v9
  s_nop 1
  v_permlane16_swap_b32 v9, v10
  s_nop 0
  v_add_f32 v9, v9, v10
  v_mul_f32 v9, 0x3b124925, v9
  v_cvt_pk_bf16_f32 v9, v9, v9
  v_lshlrev_b32 v9, 16, v9
  v_add_f32 v9, 0x3727c5ac, v9
  v_cvt_pk_bf16_f32 v9, v9, v9
  v_lshlrev_b32 v9, 16, v9
  v_sqrt_f32 v9, v9
  s_nop 0
  v_cvt_pk_bf16_f32 v9, v9, v9
  v_lshlrev_b32 v9, 16, v9
  v_rcp_f32 v10, v9
  v_cvt_pk_bf16_f32 v8, v8, v8
  v_lshlrev_b32 v8, 16, v8
  v_fma_f32 v54, -v9, v10, 1.0
  v_fma_f32 v10, v54, v10, v10
  v_sub_f32 v232, v232, v8
  v_sub_f32 v233, v233, v8
  v_sub_f32 v234, v234, v8
  v_sub_f32 v235, v235, v8
  v_sub_f32 v236, v236, v8
  v_sub_f32 v237, v237, v8
  v_sub_f32 v238, v238, v8
  v_sub_f32 v239, v239, v8
  v_sub_f32 v240, v240, v8
  v_sub_f32 v241, v241, v8
  v_sub_f32 v242, v242, v8
  v_sub_f32 v243, v243, v8
  v_sub_f32 v244, v244, v8
  v_sub_f32 v245, v245, v8
  v_sub_f32 v246, v246, v8
  v_sub_f32 v247, v247, v8
  v_cvt_pk_bf16_f32 v224, v232, v233
  v_cvt_pk_bf16_f32 v225, v234, v235
  v_cvt_pk_bf16_f32 v226, v236, v237
  v_cvt_pk_bf16_f32 v227, v238, v239
  v_cvt_pk_bf16_f32 v228, v240, v241
  v_cvt_pk_bf16_f32 v229, v242, v243
  v_cvt_pk_bf16_f32 v230, v244, v245
  v_cvt_pk_bf16_f32 v231, v246, v247
  v_lshlrev_b32 v232, 16, v224
  v_and_b32 v233, 0xffff0000, v224
  v_lshlrev_b32 v234, 16, v225
  v_and_b32 v235, 0xffff0000, v225
  v_lshlrev_b32 v236, 16, v226
  v_and_b32 v237, 0xffff0000, v226
  v_lshlrev_b32 v238, 16, v227
  v_and_b32 v239, 0xffff0000, v227
  v_lshlrev_b32 v240, 16, v228
  v_and_b32 v241, 0xffff0000, v228
  v_lshlrev_b32 v242, 16, v229
  v_and_b32 v243, 0xffff0000, v229
  v_lshlrev_b32 v244, 16, v230
  v_and_b32 v245, 0xffff0000, v230
  v_lshlrev_b32 v246, 16, v231
  v_and_b32 v247, 0xffff0000, v231
  v_mul_f32 v232, v232, v10
  v_mul_f32 v233, v233, v10
  v_mul_f32 v234, v234, v10
  v_mul_f32 v235, v235, v10
  v_mul_f32 v236, v236, v10
  v_mul_f32 v237, v237, v10
  v_mul_f32 v238, v238, v10
  v_mul_f32 v239, v239, v10
  v_mul_f32 v240, v240, v10
  v_mul_f32 v241, v241, v10
  v_mul_f32 v242, v242, v10
  v_mul_f32 v243, v243, v10
  v_mul_f32 v244, v244, v10
  v_mul_f32 v245, v245, v10
  v_mul_f32 v246, v246, v10
  v_mul_f32 v247, v247, v10
  v_cvt_pk_bf16_f32 v224, v232, v233
  v_cvt_pk_bf16_f32 v225, v234, v235
  v_cvt_pk_bf16_f32 v226, v236, v237
  v_cvt_pk_bf16_f32 v227, v238, v239
  v_cvt_pk_bf16_f32 v228, v240, v241
  v_cvt_pk_bf16_f32 v229, v242, v243
  v_cvt_pk_bf16_f32 v230, v244, v245
  v_cvt_pk_bf16_f32 v231, v246, v247
  v_mul_u32_u24 v4, 912, v3
  v_lshl_add_u32 v4, v2, 4, v4
  v_add_u32 v4, 147456, v4
  s_mov_b64 exec, s[52:53]
  ds_write_b128 v4, v[224:227]
  ds_write_b128 v4, v[228:231] offset:448
  s_mov_b64 exec, -1
  v_lshrrev_b32 v1, 4, v0
  v_and_b32 v2, 15, v0
  v_and_b32 v8, 7, v0
  v_mul_u32_u24 v5, 912, v8
  v_lshl_add_u32 v5, v1, 4, v5
  v_add_u32 v5, 147456, v5
  v_bfe_u32 v6, v2, 3, 1
  v_lshlrev_b32 v6, 1, v6
  v_and_b32 v7, 1, v1
  v_lshl_add_u32 v6, v7, 2, v6
  v_bfe_u32 v7, v2, 1, 1
  v_or_b32 v6, v6, v7
  v_lshrrev_b32 v7, 2, v2
  v_lshlrev_b32 v7, 7, v7
  v_lshl_add_u32 v7, v1, 10, v7
  v_and_b32 v54, 1, v2
  v_lshl_add_u32 v7, v54, 3, v7
  s_lshl_b32 s43, s3, 1
  v_xor_b32 v6, s43, v6
  v_lshl_add_u32 v28, v6, 4, v7
  v_add_u32 v28, 16384, v28
  v_lshrrev_b32 v6, 1, v1
  v_mul_u32_u24 v6, 18432, v6
  v_add_u32 v29, v28, v6
  v_add_u32 v30, 0x10000, v28
  v_add_u32 v31, 0x10000, v29
  s_mov_b32 s47, 4096
  s_mov_b32 s43, 16384
  s_cmp_eq_u32 s63, 1
  s_cselect_b32 s47, 196608, s47
  s_cselect_b32 s43, 7168, s43
  s_cmp_eq_u32 s63, 2
  s_cselect_b32 s47, 262144, s47
  s_cselect_b32 s43, 7168, s43
  v_mul_lo_u32 v9, s43, v8
  v_lshl_add_u32 v9, v1, 4, v9
  s_lshl_b32 s43, s62, 8
  s_add_u32 s47, s47, s43
  s_lshl_b32 s43, s3, 6
  s_add_u32 s47, s47, s43
  v_add_u32 v9, s47, v9
  s_waitcnt vmcnt(0) lgkmcnt(0)
  s_barrier
  ds_read_b128 v[64:67], v5 offset:0
  ds_read_b128 v[68:71], v5 offset:64
  ds_read_b128 v[72:75], v5 offset:128
  ds_read_b128 v[76:79], v5 offset:192
  ds_read_b128 v[80:83], v5 offset:256
  ds_read_b128 v[84:87], v5 offset:320
  ds_read_b128 v[88:91], v5 offset:384
  ds_read_b128 v[92:95], v5 offset:448
  ds_read_b128 v[96:99], v5 offset:512
  ds_read_b128 v[100:103], v5 offset:576
  ds_read_b128 v[104:107], v5 offset:640
  ds_read_b128 v[108:111], v5 offset:704
  ds_read_b128 v[112:115], v5 offset:768
  ds_read_b128 v[116:119], v5 offset:832
  ds_read_b64_tr_b16 v[120:121], v28 offset:0
  ds_read_b64_tr_b16 v[122:123], v28 offset:512
  ds_read_b64_tr_b16 v[124:125], v28 offset:4096
  ds_read_b64_tr_b16 v[126:127], v28 offset:4608
  ds_read_b64_tr_b16 v[128:129], v28 offset:8192
  ds_read_b64_tr_b16 v[130:131], v28 offset:8704
  ds_read_b64_tr_b16 v[132:133], v29 offset:12288
  ds_read_b64_tr_b16 v[134:135], v29 offset:12800
  ds_read_b64_tr_b16 v[136:137], v28 offset:34816
  ds_read_b64_tr_b16 v[138:139], v28 offset:35328
  ds_read_b64_tr_b16 v[140:141], v28 offset:38912
  ds_read_b64_tr_b16 v[142:143], v28 offset:39424
  ds_read_b64_tr_b16 v[144:145], v28 offset:43008
  ds_read_b64_tr_b16 v[146:147], v28 offset:43520
  ds_read_b64_tr_b16 v[148:149], v30 offset:0
  ds_read_b64_tr_b16 v[150:151], v30 offset:512
  ds_read_b64_tr_b16 v[152:153], v30 offset:4096
  ds_read_b64_tr_b16 v[154:155], v30 offset:4608
  ds_read_b64_tr_b16 v[156:157], v30 offset:8192
  ds_read_b64_tr_b16 v[158:159], v30 offset:8704
  ds_read_b64_tr_b16 v[160:161], v31 offset:12288
  ds_read_b64_tr_b16 v[162:163], v31 offset:12800
  ds_read_b64_tr_b16 v[164:165], v30 offset:34816
  ds_read_b64_tr_b16 v[166:167], v30 offset:35328
  ds_read_b64_tr_b16 v[168:169], v30 offset:38912
  ds_read_b64_tr_b16 v[170:171], v30 offset:39424
  ds_read_b64_tr_b16 v[172:173], v30 offset:43008
  ds_read_b64_tr_b16 v[174:175], v30 offset:43520
  s_waitcnt lgkmcnt(0)
  s_barrier
  v_mfma_f32_16x16x32_bf16 v[44:47], v[120:123], v[64:67], 0
  v_mfma_f32_16x16x32_bf16 v[48:51], v[124:127], v[68:71], 0
  v_mfma_f32_16x16x32_bf16 v[44:47], v[128:131], v[72:75], v[44:47]
  v_mfma_f32_16x16x32_bf16 v[48:51], v[132:135], v[76:79], v[48:51]
  v_mfma_f32_16x16x32_bf16 v[44:47], v[136:139], v[80:83], v[44:47]
  v_mfma_f32_16x16x32_bf16 v[48:51], v[140:143], v[84:87], v[48:51]
  v_mfma_f32_16x16x32_bf16 v[44:47], v[144:147], v[88:91], v[44:47]
  v_mfma_f32_16x16x32_bf16 v[48:51], v[148:151], v[92:95], v[48:51]
  v_mfma_f32_16x16x32_bf16 v[44:47], v[152:155], v[96:99], v[44:47]
  v_mfma_f32_16x16x32_bf16 v[48:51], v[156:159], v[100:103], v[48:51]
  v_mfma_f32_16x16x32_bf16 v[44:47], v[160:163], v[104:107], v[44:47]
  v_mfma_f32_16x16x32_bf16 v[48:51], v[164:167], v[108:111], v[48:51]
  v_mfma_f32_16x16x32_bf16 v[44:47], v[168:171], v[112:115], v[44:47]
  v_mfma_f32_16x16x32_bf16 v[48:51], v[172:175], v[116:119], v[48:51]
  s_nop 7
  v_add_f32 v44, v44, v48
  v_add_f32 v45, v45, v49
  v_add_f32 v46, v46, v50
  v_add_f32 v47, v47, v51
  v_cvt_pk_bf16_f32 v48, v44, v45
  v_cvt_pk_bf16_f32 v50, v46, v47
  s_cmp_eq_u32 s63, 1
  s_cbranch_scc0 L_pub
  v_lshlrev_b32 v44, 16, v48
  v_and_b32 v45, 0xffff0000, v48
  v_lshlrev_b32 v46, 16, v50
  v_and_b32 v47, 0xffff0000, v50
  v_mul_f32 v54, 0xbfb8aa3b, v44
  v_exp_f32 v54, v54
  s_nop 0
  v_add_f32 v54, 1.0, v54
  v_rcp_f32 v54, v54
  s_nop 0
  v_mul_f32 v44, v44, v54
  v_mul_f32 v54, 0xbfb8aa3b, v45
  v_exp_f32 v54, v54
  s_nop 0
  v_add_f32 v54, 1.0, v54
  v_rcp_f32 v54, v54
  s_nop 0
  v_mul_f32 v45, v45, v54
  v_mul_f32 v54, 0xbfb8aa3b, v46
  v_exp_f32 v54, v54
  s_nop 0
  v_add_f32 v54, 1.0, v54
  v_rcp_f32 v54, v54
  s_nop 0
  v_mul_f32 v46, v46, v54
  v_mul_f32 v54, 0xbfb8aa3b, v47
  v_exp_f32 v54, v54
  s_nop 0
  v_add_f32 v54, 1.0, v54
  v_rcp_f32 v54, v54
  s_nop 0
  v_mul_f32 v47, v47, v54
  v_cvt_pk_bf16_f32 v48, v44, v45
  v_cvt_pk_bf16_f32 v50, v46, v47
L_pub:
  v_mov_b32 v49, s41
  v_mov_b32 v51, s41
  s_mov_b32 s52, 0x00ff00ff
  s_mov_b32 s53, 0x00ff00ff
  s_mov_b64 exec, s[52:53]
  global_store_dwordx4 v9, v[48:51], s[24:25] sc1
  s_mov_b64 exec, -1
  s_mov_b32 m0, s44
  s_nop 0
  buffer_load_dwordx4 v12, s[28:31], s45 offen offset:0 nt lds
  buffer_load_dwordx4 v13, s[28:31], s45 offen offset:1024 nt lds
  buffer_load_dwordx4 v14, s[28:31], s45 offen offset:2048 nt lds
  buffer_load_dwordx4 v15, s[28:31], s45 offen offset:3072 nt lds
  s_add_u32 m0, s44, 4096
  s_nop 0
  buffer_load_dwordx4 v16, s[28:31], s45 offen offset:0 nt lds
  buffer_load_dwordx4 v17, s[28:31], s45 offen offset:1024 nt lds
  buffer_load_dwordx4 v18, s[28:31], s45 offen offset:2048 nt lds
  buffer_load_dwordx4 v19, s[28:31], s45 offen offset:3072 nt lds
  s_add_u32 m0, s44, 8192
  s_nop 0
  buffer_load_dwordx4 v20, s[32:35], s45 offen offset:0 nt lds
  buffer_load_dwordx4 v21, s[32:35], s45 offen offset:1024 nt lds
  buffer_load_dwordx4 v22, s[32:35], s45 offen offset:2048 nt lds
  buffer_load_dwordx4 v23, s[32:35], s45 offen offset:3072 nt lds
  s_add_u32 m0, s44, 12288
  s_nop 0
  buffer_load_dwordx4 v24, s[32:35], s45 offen offset:0 nt lds
  buffer_load_dwordx4 v25, s[32:35], s45 offen offset:1024 nt lds
  buffer_load_dwordx4 v26, s[32:35], s45 offen offset:2048 nt lds
  buffer_load_dwordx4 v27, s[32:35], s45 offen offset:3072 nt lds
  s_add_u32 s45, s45, 32768
L_p2b:
  s_add_u32 m0, s44, 16384
  s_nop 0
  buffer_load_dwordx4 v12, s[28:31], s45 offen offset:0 nt lds
  buffer_load_dwordx4 v13, s[28:31], s45 offen offset:1024 nt lds
  buffer_load_dwordx4 v14, s[28:31], s45 offen offset:2048 nt lds
  buffer_load_dwordx4 v15, s[28:31], s45 offen offset:3072 nt lds
  s_add_u32 m0, s44, 20480
  s_nop 0
  buffer_load_dwordx4 v16, s[28:31], s45 offen offset:0 nt lds
  buffer_load_dwordx4 v17, s[28:31], s45 offen offset:1024 nt lds
  buffer_load_dwordx4 v18, s[28:31], s45 offen offset:2048 nt lds
  buffer_load_dwordx4 v19, s[28:31], s45 offen offset:3072 nt lds
  s_add_u32 m0, s44, 24576
  s_nop 0
  buffer_load_dwordx4 v20, s[32:35], s45 offen offset:0 nt lds
  buffer_load_dwordx4 v21, s[32:35], s45 offen offset:1024 nt lds
  buffer_load_dwordx4 v22, s[32:35], s45 offen offset:2048 nt lds
  buffer_load_dwordx4 v23, s[32:35], s45 offen offset:3072 nt lds
  s_add_u32 m0, s44, 28672
  s_nop 0
  buffer_load_dwordx4 v24, s[32:35], s45 offen offset:0 nt lds
  buffer_load_dwordx4 v25, s[32:35], s45 offen offset:1024 nt lds
  buffer_load_dwordx4 v26, s[32:35], s45 offen offset:2048 nt lds
  buffer_load_dwordx4 v27, s[32:35], s45 offen offset:3072 nt lds
  s_add_u32 s45, s45, 32768
L_join:
  v_lshrrev_b32 v1, 4, v0
  v_and_b32 v2, 15, v0
  s_lshl_b32 s43, s3, 15
  v_lshlrev_b32 v3, 9, v2
  v_add_u32 v3, s43, v3
  v_xor_b32 v5, v1, v2
  v_xor_b32 v8, 0, v5
  v_lshl_add_u32 v28, v8, 4, v3
  v_xor_b32 v8, 4, v5
  v_lshl_add_u32 v29, v8, 4, v3
  v_xor_b32 v8, 8, v5
  v_lshl_add_u32 v30, v8, 4, v3
  v_xor_b32 v8, 12, v5
  v_lshl_add_u32 v31, v8, 4, v3
  v_xor_b32 v8, 16, v5
  v_lshl_add_u32 v32, v8, 4, v3
  v_xor_b32 v8, 20, v5
  v_lshl_add_u32 v33, v8, 4, v3
  v_xor_b32 v8, 24, v5
  v_lshl_add_u32 v34, v8, 4, v3
  v_xor_b32 v8, 28, v5
  v_lshl_add_u32 v35, v8, 4, v3
  v_lshrrev_b32 v5, 2, v2
  v_lshl_add_u32 v5, v1, 2, v5
  v_and_b32 v6, 3, v2
  v_lshlrev_b32 v6, 3, v6
  v_lshl_add_u32 v6, v5, 9, v6
  s_add_u32 s43, s43, 8192
  v_add_u32 v6, s43, v6
  v_and_b32 v5, 7, v5
  v_xor_b32 v8, 0, v5
  v_lshl_add_u32 v36, v8, 5, v6
  v_xor_b32 v8, 1, v5
  v_lshl_add_u32 v37, v8, 5, v6
  v_xor_b32 v8, 2, v5
  v_lshl_add_u32 v38, v8, 5, v6
  v_xor_b32 v8, 3, v5
  v_lshl_add_u32 v39, v8, 5, v6
  v_xor_b32 v8, 4, v5
  v_lshl_add_u32 v40, v8, 5, v6
  v_xor_b32 v8, 5, v5
  v_lshl_add_u32 v41, v8, 5, v6
  v_xor_b32 v8, 6, v5
  v_lshl_add_u32 v42, v8, 5, v6
  v_xor_b32 v8, 7, v5
  v_lshl_add_u32 v43, v8, 5, v6
  s_mul_i32 s43, s3, 224
  v_add_u32 v8, 0, v0
  v_mul_u32_u24 v9, 4682, v8
  v_lshrrev_b32 v9, 16, v9
  v_mul_u32_u24 v5, 14, v9
  v_sub_u32 v8, v8, v5
  v_mul_u32_u24 v9, 896, v9
  v_lshl_add_u32 v9, v8, 4, v9
  v_add_u32 v56, s43, v9
  v_add_u32 v8, 64, v0
  v_mul_u32_u24 v9, 4682, v8
  v_lshrrev_b32 v9, 16, v9
  v_mul_u32_u24 v5, 14, v9
  v_sub_u32 v8, v8, v5
  v_mul_u32_u24 v9, 896, v9
  v_lshl_add_u32 v9, v8, 4, v9
  v_add_u32 v57, s43, v9
  v_add_u32 v8, 128, v0
  v_mul_u32_u24 v9, 4682, v8
  v_lshrrev_b32 v9, 16, v9
  v_mul_u32_u24 v5, 14, v9
  v_sub_u32 v8, v8, v5
  v_mul_u32_u24 v9, 896, v9
  v_lshl_add_u32 v9, v8, 4, v9
  v_add_u32 v58, s43, v9
  v_add_u32 v8, 192, v0
  v_mul_u32_u24 v9, 4682, v8
  v_lshrrev_b32 v9, 16, v9
  v_mul_u32_u24 v5, 14, v9
  v_sub_u32 v8, v8, v5
  v_mul_u32_u24 v9, 896, v9
  v_lshl_add_u32 v9, v8, 4, v9
  v_add_u32 v59, s43, v9
  v_add_u32 v8, 256, v0
  v_mul_u32_u24 v9, 4682, v8
  v_lshrrev_b32 v9, 16, v9
  v_mul_u32_u24 v5, 14, v9
  v_sub_u32 v8, v8, v5
  v_mul_u32_u24 v9, 896, v9
  v_lshl_add_u32 v9, v8, 4, v9
  v_add_u32 v60, s43, v9
  v_add_u32 v8, 320, v0
  v_mul_u32_u24 v9, 4682, v8
  v_lshrrev_b32 v9, 16, v9
  v_mul_u32_u24 v5, 14, v9
  v_sub_u32 v8, v8, v5
  v_mul_u32_u24 v9, 896, v9
  v_lshl_add_u32 v9, v8, 4, v9
  v_add_u32 v61, s43, v9
  v_add_u32 v8, 384, v0
  v_mul_u32_u24 v9, 4682, v8
  v_lshrrev_b32 v9, 16, v9
  v_mul_u32_u24 v5, 14, v9
  v_sub_u32 v8, v8, v5
  v_mul_u32_u24 v9, 896, v9
  v_lshl_add_u32 v9, v8, 4, v9
  v_add_u32 v62, s43, v9
  s_mov_b32 s36, s12
  s_mov_b32 s37, s13
  s_mov_b32 s38, 3670016
  s_mov_b32 s39, 0x20000
  s_lshl_b32 s46, s27, 2
  s_add_u32 s46, s46, s40
  s_mul_i32 s46, s46, 114688
  v_mov_b32 v160, 0
  v_mov_b32 v161, 0
  v_mov_b32 v162, 0
  v_mov_b32 v163, 0
  v_mov_b32 v164, 0
  v_mov_b32 v165, 0
  v_mov_b32 v166, 0
  v_mov_b32 v167, 0
  v_mov_b32 v168, 0
  v_mov_b32 v169, 0
  v_mov_b32 v170, 0
  v_mov_b32 v171, 0
  v_mov_b32 v172, 0
  v_mov_b32 v173, 0
  v_mov_b32 v174, 0
  v_mov_b32 v175, 0
  v_mov_b32 v176, 0
  v_mov_b32 v177, 0
  v_mov_b32 v178, 0
  v_mov_b32 v179, 0
  v_mov_b32 v180, 0
  v_mov_b32 v181, 0
  v_mov_b32 v182, 0
  v_mov_b32 v183, 0
  v_mov_b32 v184, 0
  v_mov_b32 v185, 0
  v_mov_b32 v186, 0
  v_mov_b32 v187, 0
  v_mov_b32 v188, 0
  v_mov_b32 v189, 0
  v_mov_b32 v190, 0
  v_mov_b32 v191, 0
  v_mov_b32 v192, 0
  v_mov_b32 v193, 0
  v_mov_b32 v194, 0
  v_mov_b32 v195, 0
  v_mov_b32 v196, 0
  v_mov_b32 v197, 0
  v_mov_b32 v198, 0
  v_mov_b32 v199, 0
  v_mov_b32 v200, 0
  v_mov_b32 v201, 0
  v_mov_b32 v202, 0
  v_mov_b32 v203, 0
  v_mov_b32 v204, 0
  v_mov_b32 v205, 0
  v_mov_b32 v206, 0
  v_mov_b32 v207, 0
  v_mov_b32 v208, 0
  v_mov_b32 v209, 0
  v_mov_b32 v210, 0
  v_mov_b32 v211, 0
  v_mov_b32 v212, 0
  v_mov_b32 v213, 0
  v_mov_b32 v214, 0
  v_mov_b32 v215, 0
  v_mov_b32 v216, 0
  v_mov_b32 v217, 0
  v_mov_b32 v218, 0
  v_mov_b32 v219, 0
  v_mov_b32 v220, 0
  v_mov_b32 v221, 0
  v_mov_b32 v222, 0
  v_mov_b32 v223, 0
  v_mov_b32 v10, 0xff800000
  v_mov_b32 v11, 0
  v_and_b32 v8, 1, v2
  v_lshlrev_b32 v8, 9, v8
  v_lshl_add_u32 v8, v1, 4, v8
  v_add_u32 v8, 159744, v8
  s_barrier
  ds_read_b128 v[64:67], v8 offset:0
  ds_read_b128 v[68:71], v8 offset:64
  ds_read_b128 v[72:75], v8 offset:128
  ds_read_b128 v[76:79], v8 offset:192
  ds_read_b128 v[80:83], v8 offset:256
  ds_read_b128 v[84:87], v8 offset:320
  ds_read_b128 v[88:91], v8 offset:384
  ds_read_b128 v[92:95], v8 offset:448
  s_lshl_b32 s43, s42, 2
  s_add_u32 s43, s43, s3
  s_lshl_b32 s43, s43, 7
  s_add_u32 s43, s43, 7340032
  v_mov_b32 v224, s43
  v_mov_b32 v225, 1
  s_sub_u32 s49, s49, 2
  s_waitcnt lgkmcnt(0)
  s_waitcnt vmcnt(24)
  s_xor_b32 s51, s44, 0x4000
  ds_read_b128 v[96:99], v28
  ds_read_b128 v[100:103], v29
  ds_read_b128 v[104:107], v30
  ds_read_b128 v[108:111], v31
  ds_read_b128 v[112:115], v32
  ds_read_b128 v[116:119], v33
  ds_read_b128 v[120:123], v34
  ds_read_b128 v[124:127], v35
  v_xor_b32 v28, 0x4000, v28
  v_xor_b32 v29, 0x4000, v29
  v_xor_b32 v30, 0x4000, v30
  v_xor_b32 v31, 0x4000, v31
  v_xor_b32 v32, 0x4000, v32
  v_xor_b32 v33, 0x4000, v33
  v_xor_b32 v34, 0x4000, v34
  v_xor_b32 v35, 0x4000, v35
  s_waitcnt lgkmcnt(0)
  v_mfma_f32_16x16x32_bf16 v[44:47], v[96:99], v[64:67], 0
  v_mfma_f32_16x16x32_bf16 v[44:47], v[100:103], v[68:71], v[44:47]
  v_mfma_f32_16x16x32_bf16 v[44:47], v[104:107], v[72:75], v[44:47]
  v_mfma_f32_16x16x32_bf16 v[44:47], v[108:111], v[76:79], v[44:47]
  v_mfma_f32_16x16x32_bf16 v[44:47], v[112:115], v[80:83], v[44:47]
  v_mfma_f32_16x16x32_bf16 v[44:47], v[116:119], v[84:87], v[44:47]
  v_mfma_f32_16x16x32_bf16 v[44:47], v[120:123], v[88:91], v[44:47]
  v_mfma_f32_16x16x32_bf16 v[44:47], v[124:127], v[92:95], v[44:47]
  s_nop 7
  v_cvt_pk_bf16_f32 v48, v44, v45
  v_cvt_pk_bf16_f32 v50, v46, v47
  v_and_b32 v49, 0xffff0000, v48
  v_lshlrev_b32 v48, 16, v48
  v_and_b32 v51, 0xffff0000, v50
  v_lshlrev_b32 v50, 16, v50
  v_max3_f32 v54, v48, v49, v50
  v_max_f32 v54, v54, v51
  v_cmp_gt_f32 vcc, v54, v10
  s_cbranch_vccnz L_slow1
L_back2:
  v_sub_f32 v44, v48, v10
  v_sub_f32 v45, v49, v10
  v_sub_f32 v46, v50, v10
  v_sub_f32 v47, v51, v10
  v_mul_f32 v44, s48, v44
  v_mul_f32 v45, s48, v45
  v_mul_f32 v46, s48, v46
  v_mul_f32 v47, s48, v47
  v_exp_f32 v44, v44
  v_exp_f32 v45, v45
  v_exp_f32 v46, v46
  v_exp_f32 v47, v47
  s_nop 0
  v_cvt_pk_bf16_f32 v52, v44, v45
  v_cvt_pk_bf16_f32 v53, v46, v47
  v_add_f32 v44, v44, v45
  v_add_f32 v46, v46, v47
  v_add_f32 v11, v11, v44
  v_add_f32 v11, v11, v46
  s_waitcnt vmcnt(16)
  ds_read_b64_tr_b16 v[128:129], v36 offset:0
  ds_read_b64_tr_b16 v[130:131], v37 offset:0
  ds_read_b64_tr_b16 v[132:133], v38 offset:0
  ds_read_b64_tr_b16 v[134:135], v39 offset:0
  ds_read_b64_tr_b16 v[136:137], v40 offset:0
  ds_read_b64_tr_b16 v[138:139], v41 offset:0
  ds_read_b64_tr_b16 v[140:141], v42 offset:0
  ds_read_b64_tr_b16 v[142:143], v43 offset:0
  ds_read_b64_tr_b16 v[144:145], v36 offset:256
  ds_read_b64_tr_b16 v[146:147], v37 offset:256
  ds_read_b64_tr_b16 v[148:149], v38 offset:256
  ds_read_b64_tr_b16 v[150:151], v39 offset:256
  ds_read_b64_tr_b16 v[152:153], v40 offset:256
  ds_read_b64_tr_b16 v[154:155], v41 offset:256
  ds_read_b64_tr_b16 v[156:157], v42 offset:256
  ds_read_b64_tr_b16 v[158:159], v43 offset:256
  v_xor_b32 v36, 0x4000, v36
  v_xor_b32 v37, 0x4000, v37
  v_xor_b32 v38, 0x4000, v38
  v_xor_b32 v39, 0x4000, v39
  v_xor_b32 v40, 0x4000, v40
  v_xor_b32 v41, 0x4000, v41
  v_xor_b32 v42, 0x4000, v42
  v_xor_b32 v43, 0x4000, v43
  s_waitcnt lgkmcnt(0)
  s_xor_b32 s44, s44, 0x4000
  v_mfma_f32_16x16x16_bf16 v[160:163], v[128:129], v[52:53], v[160:163]
  v_mfma_f32_16x16x16_bf16 v[164:167], v[130:131], v[52:53], v[164:167]
  v_mfma_f32_16x16x16_bf16 v[168:171], v[132:133], v[52:53], v[168:171]
  v_mfma_f32_16x16x16_bf16 v[172:175], v[134:135], v[52:53], v[172:175]
  v_mfma_f32_16x16x16_bf16 v[176:179], v[136:137], v[52:53], v[176:179]
  v_mfma_f32_16x16x16_bf16 v[180:183], v[138:139], v[52:53], v[180:183]
  v_mfma_f32_16x16x16_bf16 v[184:187], v[140:141], v[52:53], v[184:187]
  v_mfma_f32_16x16x16_bf16 v[188:191], v[142:143], v[52:53], v[188:191]
  v_mfma_f32_16x16x16_bf16 v[192:195], v[144:145], v[52:53], v[192:195]
  v_mfma_f32_16x16x16_bf16 v[196:199], v[146:147], v[52:53], v[196:199]
  v_mfma_f32_16x16x16_bf16 v[200:203], v[148:149], v[52:53], v[200:203]
  v_mfma_f32_16x16x16_bf16 v[204:207], v[150:151], v[52:53], v[204:207]
  v_mfma_f32_16x16x16_bf16 v[208:211], v[152:153], v[52:53], v[208:211]
  v_mfma_f32_16x16x16_bf16 v[212:215], v[154:155], v[52:53], v[212:215]
  v_mfma_f32_16x16x16_bf16 v[216:219], v[156:157], v[52:53], v[216:219]
  v_mfma_f32_16x16x16_bf16 v[220:223], v[158:159], v[52:53], v[220:223]
  s_sub_u32 s49, s49, 1
L_main:
  s_waitcnt vmcnt(8)
  s_xor_b32 s51, s44, 0x4000
  s_mov_b32 m0, s51
  s_nop 0
  buffer_load_dwordx4 v12, s[28:31], s45 offen offset:0 nt lds
  buffer_load_dwordx4 v13, s[28:31], s45 offen offset:1024 nt lds
  buffer_load_dwordx4 v14, s[28:31], s45 offen offset:2048 nt lds
  buffer_load_dwordx4 v15, s[28:31], s45 offen offset:3072 nt lds
  s_add_u32 m0, s51, 4096
  s_nop 0
  buffer_load_dwordx4 v16, s[28:31], s45 offen offset:0 nt lds
  buffer_load_dwordx4 v17, s[28:31], s45 offen offset:1024 nt lds
  buffer_load_dwordx4 v18, s[28:31], s45 offen offset:2048 nt lds
  buffer_load_dwordx4 v19, s[28:31], s45 offen offset:3072 nt lds
  ds_read_b128 v[96:99], v28
  ds_read_b128 v[100:103], v29
  ds_read_b128 v[104:107], v30
  ds_read_b128 v[108:111], v31
  ds_read_b128 v[112:115], v32
  ds_read_b128 v[116:119], v33
  ds_read_b128 v[120:123], v34
  ds_read_b128 v[124:127], v35
  v_xor_b32 v28, 0x4000, v28
  v_xor_b32 v29, 0x4000, v29
  v_xor_b32 v30, 0x4000, v30
  v_xor_b32 v31, 0x4000, v31
  v_xor_b32 v32, 0x4000, v32
  v_xor_b32 v33, 0x4000, v33
  v_xor_b32 v34, 0x4000, v34
  v_xor_b32 v35, 0x4000, v35
  s_waitcnt lgkmcnt(0)
  v_mfma_f32_16x16x32_bf16 v[44:47], v[96:99], v[64:67], 0
  v_mfma_f32_16x16x32_bf16 v[44:47], v[100:103], v[68:71], v[44:47]
  v_mfma_f32_16x16x32_bf16 v[44:47], v[104:107], v[72:75], v[44:47]
  v_mfma_f32_16x16x32_bf16 v[44:47], v[108:111], v[76:79], v[44:47]
  v_mfma_f32_16x16x32_bf16 v[44:47], v[112:115], v[80:83], v[44:47]
  v_mfma_f32_16x16x32_bf16 v[44:47], v[116:119], v[84:87], v[44:47]
  v_mfma_f32_16x16x32_bf16 v[44:47], v[120:123], v[88:91], v[44:47]
  v_mfma_f32_16x16x32_bf16 v[44:47], v[124:127], v[92:95], v[44:47]
  s_nop 7
  v_cvt_pk_bf16_f32 v48, v44, v45
  v_cvt_pk_bf16_f32 v50, v46, v47
  v_and_b32 v49, 0xffff0000, v48
  v_lshlrev_b32 v48, 16, v48
  v_and_b32 v51, 0xffff0000, v50
  v_lshlrev_b32 v50, 16, v50
  v_max3_f32 v54, v48, v49, v50
  v_max_f32 v54, v54, v51
  v_cmp_gt_f32 vcc, v54, v10
  s_cbranch_vccnz L_slow3
L_back4:
  v_sub_f32 v44, v48, v10
  v_sub_f32 v45, v49, v10
  v_sub_f32 v46, v50, v10
  v_sub_f32 v47, v51, v10
  v_mul_f32 v44, s48, v44
  v_mul_f32 v45, s48, v45
  v_mul_f32 v46, s48, v46
  v_mul_f32 v47, s48, v47
  v_exp_f32 v44, v44
  v_exp_f32 v45, v45
  v_exp_f32 v46, v46
  v_exp_f32 v47, v47
  s_nop 0
  v_cvt_pk_bf16_f32 v52, v44, v45
  v_cvt_pk_bf16_f32 v53, v46, v47
  v_add_f32 v44, v44, v45
  v_add_f32 v46, v46, v47
  v_add_f32 v11, v11, v44
  v_add_f32 v11, v11, v46
  s_waitcnt vmcnt(8)
  s_add_u32 m0, s51, 8192
  s_nop 0
  buffer_load_dwordx4 v20, s[32:35], s45 offen offset:0 nt lds
  buffer_load_dwordx4 v21, s[32:35], s45 offen offset:1024 nt lds
  buffer_load_dwordx4 v22, s[32:35], s45 offen offset:2048 nt lds
  buffer_load_dwordx4 v23, s[32:35], s45 offen offset:3072 nt lds
  s_add_u32 m0, s51, 12288
  s_nop 0
  buffer_load_dwordx4 v24, s[32:35], s45 offen offset:0 nt lds
  buffer_load_dwordx4 v25, s[32:35], s45 offen offset:1024 nt lds
  buffer_load_dwordx4 v26, s[32:35], s45 offen offset:2048 nt lds
  buffer_load_dwordx4 v27, s[32:35], s45 offen offset:3072 nt lds
  s_add_u32 s45, s45, 32768
  ds_read_b64_tr_b16 v[128:129], v36 offset:0
  ds_read_b64_tr_b16 v[130:131], v37 offset:0
  ds_read_b64_tr_b16 v[132:133], v38 offset:0
  ds_read_b64_tr_b16 v[134:135], v39 offset:0
  ds_read_b64_tr_b16 v[136:137], v40 offset:0
  ds_read_b64_tr_b16 v[138:139], v41 offset:0
  ds_read_b64_tr_b16 v[140:141], v42 offset:0
  ds_read_b64_tr_b16 v[142:143], v43 offset:0
  ds_read_b64_tr_b16 v[144:145], v36 offset:256
  ds_read_b64_tr_b16 v[146:147], v37 offset:256
  ds_read_b64_tr_b16 v[148:149], v38 offset:256
  ds_read_b64_tr_b16 v[150:151], v39 offset:256
  ds_read_b64_tr_b16 v[152:153], v40 offset:256
  ds_read_b64_tr_b16 v[154:155], v41 offset:256
  ds_read_b64_tr_b16 v[156:157], v42 offset:256
  ds_read_b64_tr_b16 v[158:159], v43 offset:256
  v_xor_b32 v36, 0x4000, v36
  v_xor_b32 v37, 0x4000, v37
  v_xor_b32 v38, 0x4000, v38
  v_xor_b32 v39, 0x4000, v39
  v_xor_b32 v40, 0x4000, v40
  v_xor_b32 v41, 0x4000, v41
  v_xor_b32 v42, 0x4000, v42
  v_xor_b32 v43, 0x4000, v43
  s_waitcnt lgkmcnt(0)
  s_xor_b32 s44, s44, 0x4000
  v_mfma_f32_16x16x16_bf16 v[160:163], v[128:129], v[52:53], v[160:163]
  v_mfma_f32_16x16x16_bf16 v[164:167], v[130:131], v[52:53], v[164:167]
  v_mfma_f32_16x16x16_bf16 v[168:171], v[132:133], v[52:53], v[168:171]
  v_mfma_f32_16x16x16_bf16 v[172:175], v[134:135], v[52:53], v[172:175]
  v_mfma_f32_16x16x16_bf16 v[176:179], v[136:137], v[52:53], v[176:179]
  v_mfma_f32_16x16x16_bf16 v[180:183], v[138:139], v[52:53], v[180:183]
  v_mfma_f32_16x16x16_bf16 v[184:187], v[140:141], v[52:53], v[184:187]
  v_mfma_f32_16x16x16_bf16 v[188:191], v[142:143], v[52:53], v[188:191]
  v_mfma_f32_16x16x16_bf16 v[192:195], v[144:145], v[52:53], v[192:195]
  v_mfma_f32_16x16x16_bf16 v[196:199], v[146:147], v[52:53], v[196:199]
  v_mfma_f32_16x16x16_bf16 v[200:203], v[148:149], v[52:53], v[200:203]
  v_mfma_f32_16x16x16_bf16 v[204:207], v[150:151], v[52:53], v[204:207]
  v_mfma_f32_16x16x16_bf16 v[208:211], v[152:153], v[52:53], v[208:211]
  v_mfma_f32_16x16x16_bf16 v[212:215], v[154:155], v[52:53], v[212:215]
  v_mfma_f32_16x16x16_bf16 v[216:219], v[156:157], v[52:53], v[216:219]
  v_mfma_f32_16x16x16_bf16 v[220:223], v[158:159], v[52:53], v[220:223]
  s_sub_u32 s49, s49, 1
  s_cmp_lg_u32 s49, 0
  s_cbranch_scc1 L_main
  s_waitcnt vmcnt(8)
  s_branch L_dyna
L_dyn:
  s_waitcnt vmcnt(8)
  v_readfirstlane_b32 s43, v226
  s_cmp_ge_u32 s43, 16
  s_cbranch_scc1 L_last
  s_add_u32 s43, s43, 48
  s_lshl_b32 s45, s43, 15
L_dyna:
  s_mov_b64 exec, 1
  global_atomic_add v226, v224, v225, s[24:25] sc0
  s_mov_b64 exec, -1
  s_xor_b32 s51, s44, 0x4000
  s_mov_b32 m0, s51
  s_nop 0
  buffer_load_dwordx4 v12, s[28:31], s45 offen offset:0 nt lds
  buffer_load_dwordx4 v13, s[28:31], s45 offen offset:1024 nt lds
  buffer_load_dwordx4 v14, s[28:31], s45 offen offset:2048 nt lds
  buffer_load_dwordx4 v15, s[28:31], s45 offen offset:3072 nt lds
  s_add_u32 m0, s51, 4096
  s_nop 0
  buffer_load_dwordx4 v16, s[28:31], s45 offen offset:0 nt lds
  buffer_load_dwordx4 v17, s[28:31], s45 offen offset:1024 nt lds
  buffer_load_dwordx4 v18, s[28:31], s45 offen offset:2048 nt lds
  buffer_load_dwordx4 v19, s[28:31], s45 offen offset:3072 nt lds
  ds_read_b128 v[96:99], v28
  ds_read_b128 v[100:103], v29
  ds_read_b128 v[104:107], v30
  ds_read_b128 v[108:111], v31
  ds_read_b128 v[112:115], v32
  ds_read_b128 v[116:119], v33
  ds_read_b128 v[120:123], v34
  ds_read_b128 v[124:127], v35
  v_xor_b32 v28, 0x4000, v28
  v_xor_b32 v29, 0x4000, v29
  v_xor_b32 v30, 0x4000, v30
  v_xor_b32 v31, 0x4000, v31
  v_xor_b32 v32, 0x4000, v32
  v_xor_b32 v33, 0x4000, v33
  v_xor_b32 v34, 0x4000, v34
  v_xor_b32 v35, 0x4000, v35
  s_waitcnt lgkmcnt(0)
  v_mfma_f32_16x16x32_bf16 v[44:47], v[96:99], v[64:67], 0
  v_mfma_f32_16x16x32_bf16 v[44:47], v[100:103], v[68:71], v[44:47]
  v_mfma_f32_16x16x32_bf16 v[44:47], v[104:107], v[72:75], v[44:47]
  v_mfma_f32_16x16x32_bf16 v[44:47], v[108:111], v[76:79], v[44:47]
  v_mfma_f32_16x16x32_bf16 v[44:47], v[112:115], v[80:83], v[44:47]
  v_mfma_f32_16x16x32_bf16 v[44:47], v[116:119], v[84:87], v[44:47]
  v_mfma_f32_16x16x32_bf16 v[44:47], v[120:123], v[88:91], v[44:47]
  v_mfma_f32_16x16x32_bf16 v[44:47], v[124:127], v[92:95], v[44:47]
  s_nop 7
  v_cvt_pk_bf16_f32 v48, v44, v45
  v_cvt_pk_bf16_f32 v50, v46, v47
  v_and_b32 v49, 0xffff0000, v48
  v_lshlrev_b32 v48, 16, v48
  v_and_b32 v51, 0xffff0000, v50
  v_lshlrev_b32 v50, 16, v50
  v_max3_f32 v54, v48, v49, v50
  v_max_f32 v54, v54, v51
  v_cmp_gt_f32 vcc, v54, v10
  s_cbranch_vccnz L_slow5
L_back6:
  v_sub_f32 v44, v48, v10
  v_sub_f32 v45, v49, v10
  v_sub_f32 v46, v50, v10
  v_sub_f32 v47, v51, v10
  v_mul_f32 v44, s48, v44
  v_mul_f32 v45, s48, v45
  v_mul_f32 v46, s48, v46
  v_mul_f32 v47, s48, v47
  v_exp_f32 v44, v44
  v_exp_f32 v45, v45
  v_exp_f32 v46, v46
  v_exp_f32 v47, v47
  s_nop 0
  v_cvt_pk_bf16_f32 v52, v44, v45
  v_cvt_pk_bf16_f32 v53, v46, v47
  v_add_f32 v44, v44, v45
  v_add_f32 v46, v46, v47
  v_add_f32 v11, v11, v44
  v_add_f32 v11, v11, v46
  s_waitcnt vmcnt(9)
  s_add_u32 m0, s51, 8192
  s_nop 0
  buffer_load_dwordx4 v20, s[32:35], s45 offen offset:0 nt lds
  buffer_load_dwordx4 v21, s[32:35], s45 offen offset:1024 nt lds
  buffer_load_dwordx4 v22, s[32:35], s45 offen offset:2048 nt lds
  buffer_load_dwordx4 v23, s[32:35], s45 offen offset:3072 nt lds
  s_add_u32 m0, s51, 12288
  s_nop 0
  buffer_load_dwordx4 v24, s[32:35], s45 offen offset:0 nt lds
  buffer_load_dwordx4 v25, s[32:35], s45 offen offset:1024 nt lds
  buffer_load_dwordx4 v26, s[32:35], s45 offen offset:2048 nt lds
  buffer_load_dwordx4 v27, s[32:35], s45 offen offset:3072 nt lds
  s_add_u32 s45, s45, 32768
  ds_read_b64_tr_b16 v[128:129], v36 offset:0
  ds_read_b64_tr_b16 v[130:131], v37 offset:0
  ds_read_b64_tr_b16 v[132:133], v38 offset:0
  ds_read_b64_tr_b16 v[134:135], v39 offset:0
  ds_read_b64_tr_b16 v[136:137], v40 offset:0
  ds_read_b64_tr_b16 v[138:139], v41 offset:0
  ds_read_b64_tr_b16 v[140:141], v42 offset:0
  ds_read_b64_tr_b16 v[142:143], v43 offset:0
  ds_read_b64_tr_b16 v[144:145], v36 offset:256
  ds_read_b64_tr_b16 v[146:147], v37 offset:256
  ds_read_b64_tr_b16 v[148:149], v38 offset:256
  ds_read_b64_tr_b16 v[150:151], v39 offset:256
  ds_read_b64_tr_b16 v[152:153], v40 offset:256
  ds_read_b64_tr_b16 v[154:155], v41 offset:256
  ds_read_b64_tr_b16 v[156:157], v42 offset:256
  ds_read_b64_tr_b16 v[158:159], v43 offset:256
  v_xor_b32 v36, 0x4000, v36
  v_xor_b32 v37, 0x4000, v37
  v_xor_b32 v38, 0x4000, v38
  v_xor_b32 v39, 0x4000, v39
  v_xor_b32 v40, 0x4000, v40
  v_xor_b32 v41, 0x4000, v41
  v_xor_b32 v42, 0x4000, v42
  v_xor_b32 v43, 0x4000, v43
  s_waitcnt lgkmcnt(0)
  s_xor_b32 s44, s44, 0x4000
  v_mfma_f32_16x16x16_bf16 v[160:163], v[128:129], v[52:53], v[160:163]
  v_mfma_f32_16x16x16_bf16 v[164:167], v[130:131], v[52:53], v[164:167]
  v_mfma_f32_16x16x16_bf16 v[168:171], v[132:133], v[52:53], v[168:171]
  v_mfma_f32_16x16x16_bf16 v[172:175], v[134:135], v[52:53], v[172:175]
  v_mfma_f32_16x16x16_bf16 v[176:179], v[136:137], v[52:53], v[176:179]
  v_mfma_f32_16x16x16_bf16 v[180:183], v[138:139], v[52:53], v[180:183]
  v_mfma_f32_16x16x16_bf16 v[184:187], v[140:141], v[52:53], v[184:187]
  v_mfma_f32_16x16x16_bf16 v[188:191], v[142:143], v[52:53], v[188:191]
  v_mfma_f32_16x16x16_bf16 v[192:195], v[144:145], v[52:53], v[192:195]
  v_mfma_f32_16x16x16_bf16 v[196:199], v[146:147], v[52:53], v[196:199]
  v_mfma_f32_16x16x16_bf16 v[200:203], v[148:149], v[52:53], v[200:203]
  v_mfma_f32_16x16x16_bf16 v[204:207], v[150:151], v[52:53], v[204:207]
  v_mfma_f32_16x16x16_bf16 v[208:211], v[152:153], v[52:53], v[208:211]
  v_mfma_f32_16x16x16_bf16 v[212:215], v[154:155], v[52:53], v[212:215]
  v_mfma_f32_16x16x16_bf16 v[216:219], v[156:157], v[52:53], v[216:219]
  v_mfma_f32_16x16x16_bf16 v[220:223], v[158:159], v[52:53], v[220:223]
  s_branch L_dyn
L_last:
  s_waitcnt vmcnt(8)
  s_xor_b32 s51, s44, 0x4000
  ds_read_b128 v[96:99], v28
  ds_read_b128 v[100:103], v29
  ds_read_b128 v[104:107], v30
  ds_read_b128 v[108:111], v31
  ds_read_b128 v[112:115], v32
  ds_read_b128 v[116:119], v33
  ds_read_b128 v[120:123], v34
  ds_read_b128 v[124:127], v35
  s_add_u32 s47, s46, 0
  s_add_u32 m0, s51, 0
  s_nop 0
  buffer_load_dwordx4 v56, s[36:39], s47 offen lds
  s_add_u32 m0, s51, 1024
  s_nop 0
  buffer_load_dwordx4 v57, s[36:39], s47 offen lds
  s_add_u32 m0, s51, 2048
  s_nop 0
  buffer_load_dwordx4 v58, s[36:39], s47 offen lds
  s_add_u32 m0, s51, 3072
  s_nop 0
  buffer_load_dwordx4 v59, s[36:39], s47 offen lds
  s_add_u32 m0, s51, 4096
  s_nop 0
  buffer_load_dwordx4 v60, s[36:39], s47 offen lds
  s_add_u32 m0, s51, 5120
  s_nop 0
  buffer_load_dwordx4 v61, s[36:39], s47 offen lds
  s_add_u32 m0, s51, 6144
  s_nop 0
  buffer_load_dwordx4 v62, s[36:39], s47 offen lds
  s_add_u32 s47, s46, 28672
  s_add_u32 m0, s51, 8192
  s_nop 0
  buffer_load_dwordx4 v56, s[36:39], s47 offen lds
  s_add_u32 m0, s51, 9216
  s_nop 0
  buffer_load_dwordx4 v57, s[36:39], s47 offen lds
  s_add_u32 m0, s51, 10240
  s_nop 0
  buffer_load_dwordx4 v58, s[36:39], s47 offen lds
  s_add_u32 m0, s51, 11264
  s_nop 0
  buffer_load_dwordx4 v59, s[36:39], s47 offen lds
  s_add_u32 m0, s51, 12288
  s_nop 0
  buffer_load_dwordx4 v60, s[36:39], s47 offen lds
  s_add_u32 m0, s51, 13312
  s_nop 0
  buffer_load_dwordx4 v61, s[36:39], s47 offen lds
  s_add_u32 m0, s51, 14336
  s_nop 0
  buffer_load_dwordx4 v62, s[36:39], s47 offen lds
  v_xor_b32 v28, 0x4000, v28
  v_xor_b32 v29, 0x4000, v29
  v_xor_b32 v30, 0x4000, v30
  v_xor_b32 v31, 0x4000, v31
  v_xor_b32 v32, 0x4000, v32
  v_xor_b32 v33, 0x4000, v33
  v_xor_b32 v34, 0x4000, v34
  v_xor_b32 v35, 0x4000, v35
  s_waitcnt lgkmcnt(0)
  s_add_u32 s47, s46, 57344
  s_add_u32 m0, s44, 0
  s_nop 0
  buffer_load_dwordx4 v56, s[36:39], s47 offen lds
  s_add_u32 m0, s44, 1024
  s_nop 0
  buffer_load_dwordx4 v57, s[36:39], s47 offen lds
  s_add_u32 m0, s44, 2048
  s_nop 0
  buffer_load_dwordx4 v58, s[36:39], s47 offen lds
  s_add_u32 m0, s44, 3072
  s_nop 0
  buffer_load_dwordx4 v59, s[36:39], s47 offen lds
  s_add_u32 m0, s44, 4096
  s_nop 0
  buffer_load_dwordx4 v60, s[36:39], s47 offen lds
  s_add_u32 m0, s44, 5120
  s_nop 0
  buffer_load_dwordx4 v61, s[36:39], s47 offen lds
  s_add_u32 m0, s44, 6144
  s_nop 0
  buffer_load_dwordx4 v62, s[36:39], s47 offen lds
  v_mfma_f32_16x16x32_bf16 v[44:47], v[96:99], v[64:67], 0
  v_mfma_f32_16x16x32_bf16 v[44:47], v[100:103], v[68:71], v[44:47]
  v_mfma_f32_16x16x32_bf16 v[44:47], v[104:107], v[72:75], v[44:47]
  v_mfma_f32_16x16x32_bf16 v[44:47], v[108:111], v[76:79], v[44:47]
  v_mfma_f32_16x16x32_bf16 v[44:47], v[112:115], v[80:83], v[44:47]
  v_mfma_f32_16x16x32_bf16 v[44:47], v[116:119], v[84:87], v[44:47]
  v_mfma_f32_16x16x32_bf16 v[44:47], v[120:123], v[88:91], v[44:47]
  v_mfma_f32_16x16x32_bf16 v[44:47], v[124:127], v[92:95], v[44:47]
  s_nop 7
  v_cvt_pk_bf16_f32 v48, v44, v45
  v_cvt_pk_bf16_f32 v50, v46, v47
  v_and_b32 v49, 0xffff0000, v48
  v_lshlrev_b32 v48, 16, v48
  v_and_b32 v51, 0xffff0000, v50
  v_lshlrev_b32 v50, 16, v50
  v_max3_f32 v54, v48, v49, v50
  v_max_f32 v54, v54, v51
  v_cmp_gt_f32 vcc, v54, v10
  s_cbranch_vccnz L_slow7
L_back8:
  v_sub_f32 v44, v48, v10
  v_sub_f32 v45, v49, v10
  v_sub_f32 v46, v50, v10
  v_sub_f32 v47, v51, v10
  v_mul_f32 v44, s48, v44
  v_mul_f32 v45, s48, v45
  v_mul_f32 v46, s48, v46
  v_mul_f32 v47, s48, v47
  v_exp_f32 v44, v44
  v_exp_f32 v45, v45
  v_exp_f32 v46, v46
  v_exp_f32 v47, v47
  s_nop 0
  v_cvt_pk_bf16_f32 v52, v44, v45
  v_cvt_pk_bf16_f32 v53, v46, v47
  v_add_f32 v44, v44, v45
  v_add_f32 v46, v46, v47
  v_add_f32 v11, v11, v44
  v_add_f32 v11, v11, v46
  s_waitcnt vmcnt(21)
  ds_read_b64_tr_b16 v[128:129], v36 offset:0
  ds_read_b64_tr_b16 v[130:131], v37 offset:0
  ds_read_b64_tr_b16 v[132:133], v38 offset:0
  ds_read_b64_tr_b16 v[134:135], v39 offset:0
  ds_read_b64_tr_b16 v[136:137], v40 offset:0
  ds_read_b64_tr_b16 v[138:139], v41 offset:0
  ds_read_b64_tr_b16 v[140:141], v42 offset:0
  ds_read_b64_tr_b16 v[142:143], v43 offset:0
  ds_read_b64_tr_b16 v[144:145], v36 offset:256
  ds_read_b64_tr_b16 v[146:147], v37 offset:256
  ds_read_b64_tr_b16 v[148:149], v38 offset:256
  ds_read_b64_tr_b16 v[150:151], v39 offset:256
  ds_read_b64_tr_b16 v[152:153], v40 offset:256
  ds_read_b64_tr_b16 v[154:155], v41 offset:256
  ds_read_b64_tr_b16 v[156:157], v42 offset:256
  ds_read_b64_tr_b16 v[158:159], v43 offset:256
  v_xor_b32 v36, 0x4000, v36
  v_xor_b32 v37, 0x4000, v37
  v_xor_b32 v38, 0x4000, v38
  v_xor_b32 v39, 0x4000, v39
  v_xor_b32 v40, 0x4000, v40
  v_xor_b32 v41, 0x4000, v41
  v_xor_b32 v42, 0x4000, v42
  v_xor_b32 v43, 0x4000, v43
  s_waitcnt lgkmcnt(0)
  s_add_u32 s47, s46, 86016
  s_add_u32 m0, s44, 8192
  s_nop 0
  buffer_load_dwordx4 v56, s[36:39], s47 offen lds
  s_add_u32 m0, s44, 9216
  s_nop 0
  buffer_load_dwordx4 v57, s[36:39], s47 offen lds
  s_add_u32 m0, s44, 10240
  s_nop 0
  buffer_load_dwordx4 v58, s[36:39], s47 offen lds
  s_add_u32 m0, s44, 11264
  s_nop 0
  buffer_load_dwordx4 v59, s[36:39], s47 offen lds
  s_add_u32 m0, s44, 12288
  s_nop 0
  buffer_load_dwordx4 v60, s[36:39], s47 offen lds
  s_add_u32 m0, s44, 13312
  s_nop 0
  buffer_load_dwordx4 v61, s[36:39], s47 offen lds
  s_add_u32 m0, s44, 14336
  s_nop 0
  buffer_load_dwordx4 v62, s[36:39], s47 offen lds
  s_xor_b32 s44, s44, 0x4000
  v_mfma_f32_16x16x16_bf16 v[160:163], v[128:129], v[52:53], v[160:163]
  v_mfma_f32_16x16x16_bf16 v[164:167], v[130:131], v[52:53], v[164:167]
  v_mfma_f32_16x16x16_bf16 v[168:171], v[132:133], v[52:53], v[168:171]
  v_mfma_f32_16x16x16_bf16 v[172:175], v[134:135], v[52:53], v[172:175]
  v_mfma_f32_16x16x16_bf16 v[176:179], v[136:137], v[52:53], v[176:179]
  v_mfma_f32_16x16x16_bf16 v[180:183], v[138:139], v[52:53], v[180:183]
  v_mfma_f32_16x16x16_bf16 v[184:187], v[140:141], v[52:53], v[184:187]
  v_mfma_f32_16x16x16_bf16 v[188:191], v[142:143], v[52:53], v[188:191]
  v_mfma_f32_16x16x16_bf16 v[192:195], v[144:145], v[52:53], v[192:195]
  v_mfma_f32_16x16x16_bf16 v[196:199], v[146:147], v[52:53], v[196:199]
  v_mfma_f32_16x16x16_bf16 v[200:203], v[148:149], v[52:53], v[200:203]
  v_mfma_f32_16x16x16_bf16 v[204:207], v[150:151], v[52:53], v[204:207]
  v_mfma_f32_16x16x16_bf16 v[208:211], v[152:153], v[52:53], v[208:211]
  v_mfma_f32_16x16x16_bf16 v[212:215], v[154:155], v[52:53], v[212:215]
  v_mfma_f32_16x16x16_bf16 v[216:219], v[156:157], v[52:53], v[216:219]
  v_mfma_f32_16x16x16_bf16 v[220:223], v[158:159], v[52:53], v[220:223]
  v_mov_b32 v9, v11
  s_nop 1
  v_permlane16_swap_b32 v11, v9
  s_nop 0
  v_add_f32 v11, v11, v9
  v_mov_b32 v9, v11
  s_nop 1
  v_permlane32_swap_b32 v11, v9
  s_nop 0
  v_add_f32 v11, v11, v9
  v_and_b32 v2, 15, v0
  v_lshrrev_b32 v1, 4, v0
  s_lshl_b32 s43, s3, 15
  v_lshlrev_b32 v3, 13, v2
  v_lshl_add_u32 v3, v1, 4, v3
  s_add_u32 s47, s43, 7168
  v_add_u32 v3, s47, v3
  v_lshlrev_b32 v4, 3, v2
  s_add_u32 s47, s43, 23552
  v_add_u32 v4, s47, v4
  s_mov_b32 s52, 0x00030003
  s_mov_b32 s53, 0x00030003
  s_mov_b64 exec, s[52:53]
  ds_write_b128 v3, v[160:163] offset:0
  ds_write_b128 v3, v[164:167] offset:64
  ds_write_b128 v3, v[168:171] offset:128
  ds_write_b128 v3, v[172:175] offset:192
  ds_write_b128 v3, v[176:179] offset:256
  ds_write_b128 v3, v[180:183] offset:320
  ds_write_b128 v3, v[184:187] offset:384
  ds_write_b128 v3, v[188:191] offset:448
  ds_write_b128 v3, v[192:195] offset:512
  ds_write_b128 v3, v[196:199] offset:576
  ds_write_b128 v3, v[200:203] offset:640
  ds_write_b128 v3, v[204:207] offset:704
  ds_write_b128 v3, v[208:211] offset:768
  ds_write_b128 v3, v[212:215] offset:832
  ds_write_b128 v3, v[216:219] offset:896
  ds_write_b128 v3, v[220:223] offset:960
  s_mov_b64 exec, 3
  ds_write_b64 v4, v[10:11]
  s_mov_b64 exec, -1
  s_waitcnt lgkmcnt(0)
  s_barrier
  s_lshr_b32 s51, s3, 1
  s_and_b32 s54, s3, 1
  s_lshl_b32 s43, s51, 13
  s_lshl_b32 s47, s54, 9
  s_add_u32 s43, s43, s47
  s_add_u32 s43, s43, 7168
  v_lshlrev_b32 v3, 3, v0
  v_add_u32 v3, s43, v3
  v_add_u32 v4, 0x10000, v3
  s_lshl_b32 s43, s51, 3
  s_add_u32 s43, s43, 23552
  v_mov_b32 v5, s43
  v_add_u32 v6, 0x10000, v5
  ds_read_b64 v[224:225], v5
  ds_read_b64 v[226:227], v5 offset:32768
  ds_read_b64 v[228:229], v6
  ds_read_b64 v[230:231], v6 offset:32768
  ds_read_b64 v[232:233], v3
  ds_read_b64 v[234:235], v3 offset:32768
  ds_read_b64 v[236:237], v4
  ds_read_b64 v[238:239], v4 offset:32768
  s_lshl_b32 s43, s2, 12
  s_lshl_b32 s47, s51, 11
  s_add_u32 s43, s43, s47
  s_lshl_b32 s47, s54, 10
  s_add_u32 s43, s43, s47
  s_add_u32 s43, s43, 393216
  v_lshlrev_b32 v7, 4, v0
  v_add_u32 v7, s43, v7
  s_waitcnt lgkmcnt(4)
  v_max3_f32 v8, v224, v226, v228
  v_max_f32 v8, v8, v230
  v_sub_f32 v240, v224, v8
  v_sub_f32 v241, v226, v8
  v_sub_f32 v242, v228, v8
  v_sub_f32 v243, v230, v8
  v_mul_f32 v240, s48, v240
  v_mul_f32 v241, s48, v241
  v_mul_f32 v242, s48, v242
  v_mul_f32 v243, s48, v243
  v_exp_f32 v240, v240
  v_exp_f32 v241, v241
  v_exp_f32 v242, v242
  v_exp_f32 v243, v243
  s_waitcnt lgkmcnt(0)
  v_mul_f32 v244, v240, v232
  v_mul_f32 v246, v240, v233
  v_mul_f32 v250, v240, v225
  v_fmac_f32 v244, v241, v234
  v_fmac_f32 v246, v241, v235
  v_fmac_f32 v250, v241, v227
  v_fmac_f32 v244, v242, v236
  v_fmac_f32 v246, v242, v237
  v_fmac_f32 v250, v242, v229
  v_fmac_f32 v244, v243, v238
  v_fmac_f32 v246, v243, v239
  v_fmac_f32 v250, v243, v231
  v_mov_b32 v245, s41
  v_mov_b32 v247, s41
  global_store_dwordx4 v7, v[244:247], s[24:25] sc1
  s_lshl_b32 s43, s2, 5
  s_lshl_b32 s47, s51, 4
  s_add_u32 s43, s43, s47
  s_add_u32 s43, s43, 1441792
  v_mov_b32 v7, s43
  v_mov_b32 v248, v8
  v_mov_b32 v249, s41
  v_mov_b32 v251, s41
  s_cmp_lg_u32 s54, 0
  s_cbranch_scc1 L_skipml9
  s_mov_b64 exec, 1
  global_store_dwordx4 v7, v[248:251], s[24:25] sc1
  s_mov_b64 exec, -1
L_skipml9:
  v_and_b32 v2, 15, v0
  v_lshrrev_b32 v1, 4, v0
  v_lshrrev_b32 v3, 2, v2
  v_lshl_add_u32 v3, v1, 3, v3
  v_mul_u32_u24 v3, 224, v3
  v_and_b32 v4, 3, v2
  v_lshl_add_u32 v3, v4, 3, v3
  s_xor_b32 s43, s44, 0x4000
  v_add_u32 v4, s43, v3
  v_add_u32 v3, s44, v3
  s_lshr_b32 s51, s40, 1
  s_and_b32 s54, s40, 1
  s_lshl_b32 s43, s42, 14
  s_lshl_b32 s47, s51, 11
  s_add_u32 s43, s43, s47
  s_lshl_b32 s47, s54, 10
  s_add_u32 s43, s43, s47
  s_add_u32 s43, s43, 393216
  v_lshlrev_b32 v5, 4, v0
  v_add_u32 v5, s43, v5
  v_add_u32 v6, 0x1000, v5
  v_add_u32 v7, 0x2000, v5
  v_add_u32 v8, 0x3000, v5
  s_lshl_b32 s43, s42, 7
  s_lshl_b32 s47, s51, 4
  s_add_u32 s43, s43, s47
  s_add_u32 s43, s43, 1441792
  v_mov_b32 v9, s43
  s_waitcnt vmcnt(2)
  s_and_b32 s43, s3, 1
  s_cmp_eq_u32 s43, 0
  s_cbranch_scc1 L_wook10
  s_waitcnt vmcnt(1)
L_wook10:
  ds_read_b64_tr_b16 v[64:65], v3 offset:0
  ds_read_b64_tr_b16 v[66:67], v3 offset:896
  ds_read_b64_tr_b16 v[68:69], v3 offset:32
  ds_read_b64_tr_b16 v[70:71], v3 offset:928
  ds_read_b64_tr_b16 v[72:73], v3 offset:64
  ds_read_b64_tr_b16 v[74:75], v3 offset:960
  ds_read_b64_tr_b16 v[76:77], v3 offset:96
  ds_read_b64_tr_b16 v[78:79], v3 offset:992
  ds_read_b64_tr_b16 v[80:81], v3 offset:128
  ds_read_b64_tr_b16 v[82:83], v3 offset:1024
  ds_read_b64_tr_b16 v[84:85], v3 offset:160
  ds_read_b64_tr_b16 v[86:87], v3 offset:1056
  ds_read_b64_tr_b16 v[88:89], v3 offset:192
  ds_read_b64_tr_b16 v[90:91], v3 offset:1088
  ds_read_b64_tr_b16 v[92:93], v3 offset:8192
  ds_read_b64_tr_b16 v[94:95], v3 offset:9088
  ds_read_b64_tr_b16 v[96:97], v3 offset:8224
  ds_read_b64_tr_b16 v[98:99], v3 offset:9120
  ds_read_b64_tr_b16 v[100:101], v3 offset:8256
  ds_read_b64_tr_b16 v[102:103], v3 offset:9152
  ds_read_b64_tr_b16 v[104:105], v3 offset:8288
  ds_read_b64_tr_b16 v[106:107], v3 offset:9184
  ds_read_b64_tr_b16 v[108:109], v3 offset:8320
  ds_read_b64_tr_b16 v[110:111], v3 offset:9216
  ds_read_b64_tr_b16 v[112:113], v3 offset:8352
  ds_read_b64_tr_b16 v[114:115], v3 offset:9248
  ds_read_b64_tr_b16 v[116:117], v3 offset:8384
  ds_read_b64_tr_b16 v[118:119], v3 offset:9280
  ds_read_b64_tr_b16 v[120:121], v4 offset:0
  ds_read_b64_tr_b16 v[122:123], v4 offset:896
  ds_read_b64_tr_b16 v[124:125], v4 offset:32
  ds_read_b64_tr_b16 v[126:127], v4 offset:928
  ds_read_b64_tr_b16 v[128:129], v4 offset:64
  ds_read_b64_tr_b16 v[130:131], v4 offset:960
  ds_read_b64_tr_b16 v[132:133], v4 offset:96
  ds_read_b64_tr_b16 v[134:135], v4 offset:992
  ds_read_b64_tr_b16 v[136:137], v4 offset:128
  ds_read_b64_tr_b16 v[138:139], v4 offset:1024
  ds_read_b64_tr_b16 v[140:141], v4 offset:160
  ds_read_b64_tr_b16 v[142:143], v4 offset:1056
  ds_read_b64_tr_b16 v[144:145], v4 offset:192
  ds_read_b64_tr_b16 v[146:147], v4 offset:1088
  ds_read_b64_tr_b16 v[148:149], v4 offset:8192
  ds_read_b64_tr_b16 v[150:151], v4 offset:9088
  ds_read_b64_tr_b16 v[152:153], v4 offset:8224
  ds_read_b64_tr_b16 v[154:155], v4 offset:9120
  ds_read_b64_tr_b16 v[156:157], v4 offset:8256
  ds_read_b64_tr_b16 v[158:159], v4 offset:9152
  ds_read_b64_tr_b16 v[160:161], v4 offset:8288
  ds_read_b64_tr_b16 v[162:163], v4 offset:9184
  ds_read_b64_tr_b16 v[164:165], v4 offset:8320
  ds_read_b64_tr_b16 v[166:167], v4 offset:9216
  ds_read_b64_tr_b16 v[168:169], v4 offset:8352
  ds_read_b64_tr_b16 v[170:171], v4 offset:9248
  ds_read_b64_tr_b16 v[172:173], v4 offset:8384
  ds_read_b64_tr_b16 v[174:175], v4 offset:9280
  s_cmp_lg_u32 s3, 0
  s_cbranch_scc1 L_hopw
  s_mov_b32 s50, 262144
L_poll11:
  global_load_dwordx4 v[224:227], v5, s[24:25] sc1
  global_load_dwordx4 v[228:231], v6, s[24:25] sc1
  global_load_dwordx4 v[232:235], v7, s[24:25] sc1
  global_load_dwordx4 v[236:239], v8, s[24:25] sc1
  global_load_dwordx4 v[240:243], v9, s[24:25] offset:0 sc1
  global_load_dwordx4 v[244:247], v9, s[24:25] offset:32 sc1
  global_load_dwordx4 v[248:251], v9, s[24:25] offset:64 sc1
  global_load_dwordx4 v[252:255], v9, s[24:25] offset:96 sc1
  s_waitcnt vmcnt(0)
  v_xor_b32 v54, s41, v225
  v_xor_b32 v55, s41, v227
  v_or_b32 v54, v54, v55
  v_xor_b32 v55, s41, v229
  v_or_b32 v54, v54, v55
  v_xor_b32 v55, s41, v231
  v_or_b32 v54, v54, v55
  v_xor_b32 v55, s41, v233
  v_or_b32 v54, v54, v55
  v_xor_b32 v55, s41, v235
  v_or_b32 v54, v54, v55
  v_xor_b32 v55, s41, v237
  v_or_b32 v54, v54, v55
  v_xor_b32 v55, s41, v239
  v_or_b32 v54, v54, v55
  v_xor_b32 v55, s41, v241
  v_or_b32 v54, v54, v55
  v_xor_b32 v55, s41, v243
  v_or_b32 v54, v54, v55
  v_xor_b32 v55, s41, v245
  v_or_b32 v54, v54, v55
  v_xor_b32 v55, s41, v247
  v_or_b32 v54, v54, v55
  v_xor_b32 v55, s41, v249
  v_or_b32 v54, v54, v55
  v_xor_b32 v55, s41, v251
  v_or_b32 v54, v54, v55
  v_xor_b32 v55, s41, v253
  v_or_b32 v54, v54, v55
  v_xor_b32 v55, s41, v255
  v_or_b32 v54, v54, v55
  v_cmp_ne_u32 vcc, 0, v54
  s_cbranch_vccz L_got12
  s_sub_u32 s50, s50, 1
  s_cmp_lg_u32 s50, 0
  s_cbranch_scc1 L_poll11
L_got12:
  v_max3_f32 v54, v240, v244, v248
  v_max_f32 v54, v54, v252
  v_sub_f32 v240, v240, v54
  v_sub_f32 v244, v244, v54
  v_sub_f32 v248, v248, v54
  v_sub_f32 v252, v252, v54
  v_mul_f32 v240, s48, v240
  v_mul_f32 v244, s48, v244
  v_mul_f32 v248, s48, v248
  v_mul_f32 v252, s48, v252
  v_exp_f32 v240, v240
  v_exp_f32 v244, v244
  v_exp_f32 v248, v248
  v_exp_f32 v252, v252
  s_nop 0
  v_mul_f32 v54, v240, v242
  v_mul_f32 v44, v240, v224
  v_mul_f32 v45, v240, v226
  v_fmac_f32 v54, v244, v246
  v_fmac_f32 v44, v244, v228
  v_fmac_f32 v45, v244, v230
  v_fmac_f32 v54, v248, v250
  v_fmac_f32 v44, v248, v232
  v_fmac_f32 v45, v248, v234
  v_fmac_f32 v54, v252, v254
  v_fmac_f32 v44, v252, v236
  v_fmac_f32 v45, v252, v238
  v_rcp_f32 v55, v54
  s_nop 0
  v_fma_f32 v46, -v54, v55, 1.0
  v_fma_f32 v55, v46, v55, v55
  v_mul_f32 v44, v44, v55
  v_mul_f32 v45, v45, v55
  v_cvt_pk_bf16_f32 v44, v44, v45
  s_mov_b32 s43, 31744
  v_lshl_add_u32 v46, v0, 2, s43
  ds_write_b32 v46, v44
  s_waitcnt lgkmcnt(0)
L_hopw:
  s_mov_b32 s43, 31744
  v_lshl_add_u32 v47, v1, 4, s43
  s_barrier
  ds_read_b128 v[204:207], v47 offset:0
  ds_read_b128 v[208:211], v47 offset:64
  ds_read_b128 v[212:215], v47 offset:128
  ds_read_b128 v[216:219], v47 offset:192
  s_mul_i32 s43, s2, 3584
  s_mul_i32 s47, s3, 896
  s_add_u32 s43, s43, s47
  s_add_u32 s43, s43, 1572864
  v_lshlrev_b32 v5, 7, v2
  v_lshl_add_u32 v5, v1, 5, v5
  v_add_u32 v5, s43, v5
  v_cmp_eq_u32 s[82:83], 1, v2
  v_cmp_eq_u32 s[84:85], 2, v2
  v_cmp_eq_u32 s[86:87], 3, v2
  v_cmp_eq_u32 s[88:89], 4, v2
  v_cmp_eq_u32 s[90:91], 5, v2
  v_cmp_eq_u32 s[92:93], 6, v2
  s_waitcnt lgkmcnt(0)
  v_mfma_f32_16x16x32_bf16 v[176:179], v[64:67], v[204:207], 0
  v_mfma_f32_16x16x32_bf16 v[180:183], v[68:71], v[204:207], 0
  v_mfma_f32_16x16x32_bf16 v[184:187], v[72:75], v[204:207], 0
  v_mfma_f32_16x16x32_bf16 v[188:191], v[76:79], v[204:207], 0
  v_mfma_f32_16x16x32_bf16 v[192:195], v[80:83], v[204:207], 0
  v_mfma_f32_16x16x32_bf16 v[196:199], v[84:87], v[204:207], 0
  v_mfma_f32_16x16x32_bf16 v[200:203], v[88:91], v[204:207], 0
  v_mfma_f32_16x16x32_bf16 v[176:179], v[92:95], v[208:211], v[176:179]
  v_mfma_f32_16x16x32_bf16 v[180:183], v[96:99], v[208:211], v[180:183]
  v_mfma_f32_16x16x32_bf16 v[184:187], v[100:103], v[208:211], v[184:187]
  v_mfma_f32_16x16x32_bf16 v[188:191], v[104:107], v[208:211], v[188:191]
  v_mfma_f32_16x16x32_bf16 v[192:195], v[108:111], v[208:211], v[192:195]
  v_mfma_f32_16x16x32_bf16 v[196:199], v[112:115], v[208:211], v[196:199]
  v_mfma_f32_16x16x32_bf16 v[200:203], v[116:119], v[208:211], v[200:203]
  v_mfma_f32_16x16x32_bf16 v[176:179], v[120:123], v[212:215], v[176:179]
  v_mfma_f32_16x16x32_bf16 v[180:183], v[124:127], v[212:215], v[180:183]
  v_mfma_f32_16x16x32_bf16 v[184:187], v[128:131], v[212:215], v[184:187]
  v_mfma_f32_16x16x32_bf16 v[188:191], v[132:135], v[212:215], v[188:191]
  v_mfma_f32_16x16x32_bf16 v[192:195], v[136:139], v[212:215], v[192:195]
  v_mfma_f32_16x16x32_bf16 v[196:199], v[140:143], v[212:215], v[196:199]
  v_mfma_f32_16x16x32_bf16 v[200:203], v[144:147], v[212:215], v[200:203]
  v_mfma_f32_16x16x32_bf16 v[176:179], v[148:151], v[216:219], v[176:179]
  v_mfma_f32_16x16x32_bf16 v[180:183], v[152:155], v[216:219], v[180:183]
  v_mfma_f32_16x16x32_bf16 v[184:187], v[156:159], v[216:219], v[184:187]
  v_mfma_f32_16x16x32_bf16 v[188:191], v[160:163], v[216:219], v[188:191]
  v_mfma_f32_16x16x32_bf16 v[192:195], v[164:167], v[216:219], v[192:195]
  v_mfma_f32_16x16x32_bf16 v[196:199], v[168:171], v[216:219], v[196:199]
  v_mfma_f32_16x16x32_bf16 v[200:203], v[172:175], v[216:219], v[200:203]
  v_mov_b32 v225, s41
  v_mov_b32 v227, s41
  v_mov_b32 v229, s41
  v_mov_b32 v231, s41
  s_nop 5
  v_mov_b32 v224, v176
  v_mov_b32 v226, v177
  v_mov_b32 v228, v178
  v_mov_b32 v230, v179
  v_cndmask_b32 v224, v224, v180, s[82:83]
  v_cndmask_b32 v226, v226, v181, s[82:83]
  v_cndmask_b32 v228, v228, v182, s[82:83]
  v_cndmask_b32 v230, v230, v183, s[82:83]
  v_cndmask_b32 v224, v224, v184, s[84:85]
  v_cndmask_b32 v226, v226, v185, s[84:85]
  v_cndmask_b32 v228, v228, v186, s[84:85]
  v_cndmask_b32 v230, v230, v187, s[84:85]
  v_cndmask_b32 v224, v224, v188, s[86:87]
  v_cndmask_b32 v226, v226, v189, s[86:87]
  v_cndmask_b32 v228, v228, v190, s[86:87]
  v_cndmask_b32 v230, v230, v191, s[86:87]
  v_cndmask_b32 v224, v224, v192, s[88:89]
  v_cndmask_b32 v226, v226, v193, s[88:89]
  v_cndmask_b32 v228, v228, v194, s[88:89]
  v_cndmask_b32 v230, v230, v195, s[88:89]
  v_cndmask_b32 v224, v224, v196, s[90:91]
  v_cndmask_b32 v226, v226, v197, s[90:91]
  v_cndmask_b32 v228, v228, v198, s[90:91]
  v_cndmask_b32 v230, v230, v199, s[90:91]
  v_cndmask_b32 v224, v224, v200, s[92:93]
  v_cndmask_b32 v226, v226, v201, s[92:93]
  v_cndmask_b32 v228, v228, v202, s[92:93]
  v_cndmask_b32 v230, v230, v203, s[92:93]
  v_cmp_gt_u32 vcc, 7, v2
  s_and_saveexec_b64 s[52:53], vcc
  global_store_dwordx4 v5, v[224:227], s[24:25] sc1
  global_store_dwordx4 v5, v[228:231], s[24:25] offset:16 sc1
  s_mov_b64 exec, -1
  s_endpgm
L_slow1:
  v_mov_b32 v55, v54
  s_nop 1
  v_permlane16_swap_b32 v54, v55
  s_nop 0
  v_max_f32 v54, v54, v55
  v_mov_b32 v55, v54
  s_nop 1
  v_permlane32_swap_b32 v54, v55
  s_nop 0
  v_max_f32 v54, v54, v55
  v_max_f32 v54, v54, v10
  v_sub_f32 v55, v10, v54
  v_mul_f32 v55, s48, v55
  v_exp_f32 v55, v55
  v_mov_b32 v10, v54
  v_mul_f32 v11, v11, v55
  v_mul_f32 v160, v160, v55
  v_mul_f32 v161, v161, v55
  v_mul_f32 v162, v162, v55
  v_mul_f32 v163, v163, v55
  v_mul_f32 v164, v164, v55
  v_mul_f32 v165, v165, v55
  v_mul_f32 v166, v166, v55
  v_mul_f32 v167, v167, v55
  v_mul_f32 v168, v168, v55
  v_mul_f32 v169, v169, v55
  v_mul_f32 v170, v170, v55
  v_mul_f32 v171, v171, v55
  v_mul_f32 v172, v172, v55
  v_mul_f32 v173, v173, v55
  v_mul_f32 v174, v174, v55
  v_mul_f32 v175, v175, v55
  v_mul_f32 v176, v176, v55
  v_mul_f32 v177, v177, v55
  v_mul_f32 v178, v178, v55
  v_mul_f32 v179, v179, v55
  v_mul_f32 v180, v180, v55
  v_mul_f32 v181, v181, v55
  v_mul_f32 v182, v182, v55
  v_mul_f32 v183, v183, v55
  v_mul_f32 v184, v184, v55
  v_mul_f32 v185, v185, v55
  v_mul_f32 v186, v186, v55
  v_mul_f32 v187, v187, v55
  v_mul_f32 v188, v188, v55
  v_mul_f32 v189, v189, v55
  v_mul_f32 v190, v190, v55
  v_mul_f32 v191, v191, v55
  v_mul_f32 v192, v192, v55
  v_mul_f32 v193, v193, v55
  v_mul_f32 v194, v194, v55
  v_mul_f32 v195, v195, v55
  v_mul_f32 v196, v196, v55
  v_mul_f32 v197, v197, v55
  v_mul_f32 v198, v198, v55
  v_mul_f32 v199, v199, v55
  v_mul_f32 v200, v200, v55
  v_mul_f32 v201, v201, v55
  v_mul_f32 v202, v202, v55
  v_mul_f32 v203, v203, v55
  v_mul_f32 v204, v204, v55
  v_mul_f32 v205, v205, v55
  v_mul_f32 v206, v206, v55
  v_mul_f32 v207, v207, v55
  v_mul_f32 v208, v208, v55
  v_mul_f32 v209, v209, v55
  v_mul_f32 v210, v210, v55
  v_mul_f32 v211, v211, v55
  v_mul_f32 v212, v212, v55
  v_mul_f32 v213, v213, v55
  v_mul_f32 v214, v214, v55
  v_mul_f32 v215, v215, v55
  v_mul_f32 v216, v216, v55
  v_mul_f32 v217, v217, v55
  v_mul_f32 v218, v218, v55
  v_mul_f32 v219, v219, v55
  v_mul_f32 v220, v220, v55
  v_mul_f32 v221, v221, v55
  v_mul_f32 v222, v222, v55
  v_mul_f32 v223, v223, v55
  s_branch L_back2
L_slow3:
  v_mov_b32 v55, v54
  s_nop 1
  v_permlane16_swap_b32 v54, v55
  s_nop 0
  v_max_f32 v54, v54, v55
  v_mov_b32 v55, v54
  s_nop 1
  v_permlane32_swap_b32 v54, v55
  s_nop 0
  v_max_f32 v54, v54, v55
  v_max_f32 v54, v54, v10
  v_sub_f32 v55, v10, v54
  v_mul_f32 v55, s48, v55
  v_exp_f32 v55, v55
  v_mov_b32 v10, v54
  v_mul_f32 v11, v11, v55
  v_mul_f32 v160, v160, v55
  v_mul_f32 v161, v161, v55
  v_mul_f32 v162, v162, v55
  v_mul_f32 v163, v163, v55
  v_mul_f32 v164, v164, v55
  v_mul_f32 v165, v165, v55
  v_mul_f32 v166, v166, v55
  v_mul_f32 v167, v167, v55
  v_mul_f32 v168, v168, v55
  v_mul_f32 v169, v169, v55
  v_mul_f32 v170, v170, v55
  v_mul_f32 v171, v171, v55
  v_mul_f32 v172, v172, v55
  v_mul_f32 v173, v173, v55
  v_mul_f32 v174, v174, v55
  v_mul_f32 v175, v175, v55
  v_mul_f32 v176, v176, v55
  v_mul_f32 v177, v177, v55
  v_mul_f32 v178, v178, v55
  v_mul_f32 v179, v179, v55
  v_mul_f32 v180, v180, v55
  v_mul_f32 v181, v181, v55
  v_mul_f32 v182, v182, v55
  v_mul_f32 v183, v183, v55
  v_mul_f32 v184, v184, v55
  v_mul_f32 v185, v185, v55
  v_mul_f32 v186, v186, v55
  v_mul_f32 v187, v187, v55
  v_mul_f32 v188, v188, v55
  v_mul_f32 v189, v189, v55
  v_mul_f32 v190, v190, v55
  v_mul_f32 v191, v191, v55
  v_mul_f32 v192, v192, v55
  v_mul_f32 v193, v193, v55
  v_mul_f32 v194, v194, v55
  v_mul_f32 v195, v195, v55
  v_mul_f32 v196, v196, v55
  v_mul_f32 v197, v197, v55
  v_mul_f32 v198, v198, v55
  v_mul_f32 v199, v199, v55
  v_mul_f32 v200, v200, v55
  v_mul_f32 v201, v201, v55
  v_mul_f32 v202, v202, v55
  v_mul_f32 v203, v203, v55
  v_mul_f32 v204, v204, v55
  v_mul_f32 v205, v205, v55
  v_mul_f32 v206, v206, v55
  v_mul_f32 v207, v207, v55
  v_mul_f32 v208, v208, v55
  v_mul_f32 v209, v209, v55
  v_mul_f32 v210, v210, v55
  v_mul_f32 v211, v211, v55
  v_mul_f32 v212, v212, v55
  v_mul_f32 v213, v213, v55
  v_mul_f32 v214, v214, v55
  v_mul_f32 v215, v215, v55
  v_mul_f32 v216, v216, v55
  v_mul_f32 v217, v217, v55
  v_mul_f32 v218, v218, v55
  v_mul_f32 v219, v219, v55
  v_mul_f32 v220, v220, v55
  v_mul_f32 v221, v221, v55
  v_mul_f32 v222, v222, v55
  v_mul_f32 v223, v223, v55
  s_branch L_back4
L_slow5:
  v_mov_b32 v55, v54
  s_nop 1
  v_permlane16_swap_b32 v54, v55
  s_nop 0
  v_max_f32 v54, v54, v55
  v_mov_b32 v55, v54
  s_nop 1
  v_permlane32_swap_b32 v54, v55
  s_nop 0
  v_max_f32 v54, v54, v55
  v_max_f32 v54, v54, v10
  v_sub_f32 v55, v10, v54
  v_mul_f32 v55, s48, v55
  v_exp_f32 v55, v55
  v_mov_b32 v10, v54
  v_mul_f32 v11, v11, v55
  v_mul_f32 v160, v160, v55
  v_mul_f32 v161, v161, v55
  v_mul_f32 v162, v162, v55
  v_mul_f32 v163, v163, v55
  v_mul_f32 v164, v164, v55
  v_mul_f32 v165, v165, v55
  v_mul_f32 v166, v166, v55
  v_mul_f32 v167, v167, v55
  v_mul_f32 v168, v168, v55
  v_mul_f32 v169, v169, v55
  v_mul_f32 v170, v170, v55
  v_mul_f32 v171, v171, v55
  v_mul_f32 v172, v172, v55
  v_mul_f32 v173, v173, v55
  v_mul_f32 v174, v174, v55
  v_mul_f32 v175, v175, v55
  v_mul_f32 v176, v176, v55
  v_mul_f32 v177, v177, v55
  v_mul_f32 v178, v178, v55
  v_mul_f32 v179, v179, v55
  v_mul_f32 v180, v180, v55
  v_mul_f32 v181, v181, v55
  v_mul_f32 v182, v182, v55
  v_mul_f32 v183, v183, v55
  v_mul_f32 v184, v184, v55
  v_mul_f32 v185, v185, v55
  v_mul_f32 v186, v186, v55
  v_mul_f32 v187, v187, v55
  v_mul_f32 v188, v188, v55
  v_mul_f32 v189, v189, v55
  v_mul_f32 v190, v190, v55
  v_mul_f32 v191, v191, v55
  v_mul_f32 v192, v192, v55
  v_mul_f32 v193, v193, v55
  v_mul_f32 v194, v194, v55
  v_mul_f32 v195, v195, v55
  v_mul_f32 v196, v196, v55
  v_mul_f32 v197, v197, v55
  v_mul_f32 v198, v198, v55
  v_mul_f32 v199, v199, v55
  v_mul_f32 v200, v200, v55
  v_mul_f32 v201, v201, v55
  v_mul_f32 v202, v202, v55
  v_mul_f32 v203, v203, v55
  v_mul_f32 v204, v204, v55
  v_mul_f32 v205, v205, v55
  v_mul_f32 v206, v206, v55
  v_mul_f32 v207, v207, v55
  v_mul_f32 v208, v208, v55
  v_mul_f32 v209, v209, v55
  v_mul_f32 v210, v210, v55
  v_mul_f32 v211, v211, v55
  v_mul_f32 v212, v212, v55
  v_mul_f32 v213, v213, v55
  v_mul_f32 v214, v214, v55
  v_mul_f32 v215, v215, v55
  v_mul_f32 v216, v216, v55
  v_mul_f32 v217, v217, v55
  v_mul_f32 v218, v218, v55
  v_mul_f32 v219, v219, v55
  v_mul_f32 v220, v220, v55
  v_mul_f32 v221, v221, v55
  v_mul_f32 v222, v222, v55
  v_mul_f32 v223, v223, v55
  s_branch L_back6
L_slow7:
  v_mov_b32 v55, v54
  s_nop 1
  v_permlane16_swap_b32 v54, v55
  s_nop 0
  v_max_f32 v54, v54, v55
  v_mov_b32 v55, v54
  s_nop 1
  v_permlane32_swap_b32 v54, v55
  s_nop 0
  v_max_f32 v54, v54, v55
  v_max_f32 v54, v54, v10
  v_sub_f32 v55, v10, v54
  v_mul_f32 v55, s48, v55
  v_exp_f32 v55, v55
  v_mov_b32 v10, v54
  v_mul_f32 v11, v11, v55
  v_mul_f32 v160, v160, v55
  v_mul_f32 v161, v161, v55
  v_mul_f32 v162, v162, v55
  v_mul_f32 v163, v163, v55
  v_mul_f32 v164, v164, v55
  v_mul_f32 v165, v165, v55
  v_mul_f32 v166, v166, v55
  v_mul_f32 v167, v167, v55
  v_mul_f32 v168, v168, v55
  v_mul_f32 v169, v169, v55
  v_mul_f32 v170, v170, v55
  v_mul_f32 v171, v171, v55
  v_mul_f32 v172, v172, v55
  v_mul_f32 v173, v173, v55
  v_mul_f32 v174, v174, v55
  v_mul_f32 v175, v175, v55
  v_mul_f32 v176, v176, v55
  v_mul_f32 v177, v177, v55
  v_mul_f32 v178, v178, v55
  v_mul_f32 v179, v179, v55
  v_mul_f32 v180, v180, v55
  v_mul_f32 v181, v181, v55
  v_mul_f32 v182, v182, v55
  v_mul_f32 v183, v183, v55
  v_mul_f32 v184, v184, v55
  v_mul_f32 v185, v185, v55
  v_mul_f32 v186, v186, v55
  v_mul_f32 v187, v187, v55
  v_mul_f32 v188, v188, v55
  v_mul_f32 v189, v189, v55
  v_mul_f32 v190, v190, v55
  v_mul_f32 v191, v191, v55
  v_mul_f32 v192, v192, v55
  v_mul_f32 v193, v193, v55
  v_mul_f32 v194, v194, v55
  v_mul_f32 v195, v195, v55
  v_mul_f32 v196, v196, v55
  v_mul_f32 v197, v197, v55
  v_mul_f32 v198, v198, v55
  v_mul_f32 v199, v199, v55
  v_mul_f32 v200, v200, v55
  v_mul_f32 v201, v201, v55
  v_mul_f32 v202, v202, v55
  v_mul_f32 v203, v203, v55
  v_mul_f32 v204, v204, v55
  v_mul_f32 v205, v205, v55
  v_mul_f32 v206, v206, v55
  v_mul_f32 v207, v207, v55
  v_mul_f32 v208, v208, v55
  v_mul_f32 v209, v209, v55
  v_mul_f32 v210, v210, v55
  v_mul_f32 v211, v211, v55
  v_mul_f32 v212, v212, v55
  v_mul_f32 v213, v213, v55
  v_mul_f32 v214, v214, v55
  v_mul_f32 v215, v215, v55
  v_mul_f32 v216, v216, v55
  v_mul_f32 v217, v217, v55
  v_mul_f32 v218, v218, v55
  v_mul_f32 v219, v219, v55
  v_mul_f32 v220, v220, v55
  v_mul_f32 v221, v221, v55
  v_mul_f32 v222, v222, v55
  v_mul_f32 v223, v223, v55
  s_branch L_back8
L_service:
  s_setprio 3
  s_lshl_b32 s43, s26, 14
  s_lshl_b32 s47, s27, 11
  s_add_u32 s43, s43, s47
  s_add_u32 s43, s43, 4096
  v_lshl_add_u32 v10, v0, 4, s43
  v_lshlrev_b32 v11, 3, v0
  v_add_u32 v11, 159744, v11
  s_waitcnt lgkmcnt(0)
  s_add_u32 s41, s41, 0x9e3779b9
  s_cmp_eq_u32 s60, 0
  s_cbranch_scc1 L_snob1
  s_barrier
  s_barrier
L_snob1:
  s_mov_b32 s50, 262144
L_poll13:
  global_load_dwordx4 v[176:179], v10, s[24:25] sc1
  global_load_dwordx4 v[180:183], v10, s[24:25] offset:1024 sc1
  s_waitcnt vmcnt(0)
  v_xor_b32 v54, s41, v177
  v_xor_b32 v55, s41, v179
  v_or_b32 v54, v54, v55
  v_xor_b32 v55, s41, v181
  v_or_b32 v54, v54, v55
  v_xor_b32 v55, s41, v183
  v_or_b32 v54, v54, v55
  v_cmp_ne_u32 vcc, 0, v54
  s_cbranch_vccz L_got14
  s_sub_u32 s50, s50, 1
  s_cmp_lg_u32 s50, 0
  s_cbranch_scc1 L_poll13
L_got14:
  v_mov_b32 v177, v178
  v_mov_b32 v181, v182
  s_nop 0
  ds_write_b64 v11, v[176:177]
  ds_write_b64 v11, v[180:181] offset:512
  s_waitcnt lgkmcnt(0)
  s_barrier
  v_mov_b32 v20, 0
  v_mov_b32 v21, 1
  s_mov_b64 exec, 1
  global_atomic_add v19, v20, v21, s[14:15] sc0
  s_mov_b64 exec, -1
  v_lshrrev_b32 v1, 4, v0
  v_and_b32 v4, 15, v0
  v_and_b32 v8, 7, v0
  s_cmp_eq_u32 s94, 1
  s_cbranch_scc1 L_job0
  s_cmp_lg_u32 s94, 3
  s_cbranch_scc1 L_nojob
  s_cmp_ge_u32 s95, 34
  s_cbranch_scc1 L_nojob
  s_add_u32 s57, s95, 64
  s_branch L_job
L_job0:
  s_mov_b32 s57, s95
L_job:
  s_mul_i32 s58, s57, 9363
  s_lshr_b32 s58, s58, 16
  s_mul_i32 s59, s58, 7
  s_sub_u32 s59, s57, s59
  s_mov_b32 s28, s20
  s_mov_b32 s29, s21
  s_mov_b32 s30, 1605632
  s_mov_b32 s31, 0x20000
  v_lshrrev_b32 v5, 3, v0
  v_mul_u32_u24 v5, 896, v5
  v_bfe_u32 v6, v0, 4, 1
  v_lshlrev_b32 v6, 1, v6
  v_and_b32 v7, 7, v0
  v_xor_b32 v6, v6, v7
  v_lshl_add_u32 v5, v6, 4, v5
  v_xor_b32 v6, 64, v5
  s_mul_i32 s47, s58, 114688
  s_lshl_b32 s43, s59, 7
  s_add_u32 s47, s47, s43
  s_mov_b32 m0, 131072
  s_nop 0
  buffer_load_dwordx4 v5, s[28:31], s47 offen nt lds
  s_add_u32 s47, s47, 7168
  s_mov_b32 m0, 132096
  s_nop 0
  buffer_load_dwordx4 v6, s[28:31], s47 offen nt lds
  s_add_u32 s47, s47, 7168
  s_mov_b32 m0, 133120
  s_nop 0
  buffer_load_dwordx4 v5, s[28:31], s47 offen nt lds
  s_add_u32 s47, s47, 7168
  s_mov_b32 m0, 134144
  s_nop 0
  buffer_load_dwordx4 v6, s[28:31], s47 offen nt lds
  s_add_u32 s47, s47, 7168
  s_mov_b32 m0, 135168
  s_nop 0
  buffer_load_dwordx4 v5, s[28:31], s47 offen nt lds
  s_add_u32 s47, s47, 7168
  s_mov_b32 m0, 136192
  s_nop 0
  buffer_load_dwordx4 v6, s[28:31], s47 offen nt lds
  s_add_u32 s47, s47, 7168
  s_mov_b32 m0, 137216
  s_nop 0
  buffer_load_dwordx4 v5, s[28:31], s47 offen nt lds
  s_add_u32 s47, s47, 7168
  s_mov_b32 m0, 138240
  s_nop 0
  buffer_load_dwordx4 v6, s[28:31], s47 offen nt lds
  s_add_u32 s47, s47, 7168
  s_mov_b32 m0, 139264
  s_nop 0
  buffer_load_dwordx4 v5, s[28:31], s47 offen nt lds
  s_add_u32 s47, s47, 7168
  s_mov_b32 m0, 140288
  s_nop 0
  buffer_load_dwordx4 v6, s[28:31], s47 offen nt lds
  s_add_u32 s47, s47, 7168
  s_mov_b32 m0, 141312
  s_nop 0
  buffer_load_dwordx4 v5, s[28:31], s47 offen nt lds
  s_add_u32 s47, s47, 7168
  s_mov_b32 m0, 142336
  s_nop 0
  buffer_load_dwordx4 v6, s[28:31], s47 offen nt lds
  s_add_u32 s47, s47, 7168
  s_mov_b32 m0, 143360
  s_nop 0
  buffer_load_dwordx4 v5, s[28:31], s47 offen nt lds
  s_add_u32 s47, s47, 7168
  s_mov_b32 m0, 144384
  s_nop 0
  buffer_load_dwordx4 v6, s[28:31], s47 offen nt lds
  s_add_u32 s47, s47, 7168
  s_mov_b32 m0, 145408
  s_nop 0
  buffer_load_dwordx4 v5, s[28:31], s47 offen nt lds
  s_add_u32 s47, s47, 7168
  s_mov_b32 m0, 146432
  s_nop 0
  buffer_load_dwordx4 v6, s[28:31], s47 offen nt lds
  v_lshrrev_b32 v12, 5, v0
  v_mul_u32_u24 v13, 7168, v12
  v_and_b32 v14, 31, v0
  v_lshl_add_u32 v13, v14, 4, v13
  s_lshl_b32 s43, s58, 9
  s_add_u32 s43, s43, 196608
  v_add_u32 v22, s43, v13
  v_add_u32 v23, 14336, v22
  v_add_u32 v24, 28672, v22
  v_add_u32 v25, 43008, v22
  v_add_u32 v26, 65536, v22
  v_add_u32 v27, 65536, v23
  v_add_u32 v28, 65536, v24
  v_add_u32 v29, 65536, v25
  v_mul_u32_u24 v12, 272, v12
  v_lshl_add_u32 v12, v14, 3, v12
  v_add_u32 v12, 154880, v12
  s_mov_b32 s50, 262144
L_poll15:
  global_load_dwordx4 v[176:179], v22, s[24:25] sc1
  global_load_dwordx4 v[180:183], v23, s[24:25] sc1
  global_load_dwordx4 v[184:187], v24, s[24:25] sc1
  global_load_dwordx4 v[188:191], v25, s[24:25] sc1
  global_load_dwordx4 v[192:195], v26, s[24:25] sc1
  global_load_dwordx4 v[196:199], v27, s[24:25] sc1
  global_load_dwordx4 v[200:203], v28, s[24:25] sc1
  global_load_dwordx4 v[204:207], v29, s[24:25] sc1
  s_waitcnt vmcnt(0)
  v_xor_b32 v54, s41, v177
  v_xor_b32 v55, s41, v179
  v_or_b32 v54, v54, v55
  v_xor_b32 v55, s41, v181
  v_or_b32 v54, v54, v55
  v_xor_b32 v55, s41, v183
  v_or_b32 v54, v54, v55
  v_xor_b32 v55, s41, v185
  v_or_b32 v54, v54, v55
  v_xor_b32 v55, s41, v187
  v_or_b32 v54, v54, v55
  v_xor_b32 v55, s41, v189
  v_or_b32 v54, v54, v55
  v_xor_b32 v55, s41, v191
  v_or_b32 v54, v54, v55
  v_xor_b32 v55, s41, v193
  v_or_b32 v54, v54, v55
  v_xor_b32 v55, s41, v195
  v_or_b32 v54, v54, v55
  v_xor_b32 v55, s41, v197
  v_or_b32 v54, v54, v55
  v_xor_b32 v55, s41, v199
  v_or_b32 v54, v54, v55
  v_xor_b32 v55, s41, v201
  v_or_b32 v54, v54, v55
  v_xor_b32 v55, s41, v203
  v_or_b32 v54, v54, v55
  v_xor_b32 v55, s41, v205
  v_or_b32 v54, v54, v55
  v_xor_b32 v55, s41, v207
  v_or_b32 v54, v54, v55
  v_cmp_ne_u32 vcc, 0, v54
  s_cbranch_vccz L_got16
  s_sub_u32 s50, s50, 1
  s_cmp_lg_u32 s50, 0
  s_cbranch_scc1 L_poll15
L_got16:
  v_lshlrev_b32 v54, 16, v176
  v_lshlrev_b32 v55, 16, v192
  v_mul_f32 v54, v54, v55
  v_and_b32 v55, 0xffff0000, v176
  v_and_b32 v192, 0xffff0000, v192
  v_mul_f32 v55, v55, v192
  v_cvt_pk_bf16_f32 v44, v54, v55
  v_lshlrev_b32 v54, 16, v178
  v_lshlrev_b32 v55, 16, v194
  v_mul_f32 v54, v54, v55
  v_and_b32 v55, 0xffff0000, v178
  v_and_b32 v194, 0xffff0000, v194
  v_mul_f32 v55, v55, v194
  v_cvt_pk_bf16_f32 v45, v54, v55
  v_lshlrev_b32 v54, 16, v180
  v_lshlrev_b32 v55, 16, v196
  v_mul_f32 v54, v54, v55
  v_and_b32 v55, 0xffff0000, v180
  v_and_b32 v196, 0xffff0000, v196
  v_mul_f32 v55, v55, v196
  v_cvt_pk_bf16_f32 v46, v54, v55
  v_lshlrev_b32 v54, 16, v182
  v_lshlrev_b32 v55, 16, v198
  v_mul_f32 v54, v54, v55
  v_and_b32 v55, 0xffff0000, v182
  v_and_b32 v198, 0xffff0000, v198
  v_mul_f32 v55, v55, v198
  v_cvt_pk_bf16_f32 v47, v54, v55
  v_lshlrev_b32 v54, 16, v184
  v_lshlrev_b32 v55, 16, v200
  v_mul_f32 v54, v54, v55
  v_and_b32 v55, 0xffff0000, v184
  v_and_b32 v200, 0xffff0000, v200
  v_mul_f32 v55, v55, v200
  v_cvt_pk_bf16_f32 v48, v54, v55
  v_lshlrev_b32 v54, 16, v186
  v_lshlrev_b32 v55, 16, v202
  v_mul_f32 v54, v54, v55
  v_and_b32 v55, 0xffff0000, v186
  v_and_b32 v202, 0xffff0000, v202
  v_mul_f32 v55, v55, v202
  v_cvt_pk_bf16_f32 v49, v54, v55
  v_lshlrev_b32 v54, 16, v188
  v_lshlrev_b32 v55, 16, v204
  v_mul_f32 v54, v54, v55
  v_and_b32 v55, 0xffff0000, v188
  v_and_b32 v204, 0xffff0000, v204
  v_mul_f32 v55, v55, v204
  v_cvt_pk_bf16_f32 v50, v54, v55
  v_lshlrev_b32 v54, 16, v190
  v_lshlrev_b32 v55, 16, v206
  v_mul_f32 v54, v54, v55
  v_and_b32 v55, 0xffff0000, v190
  v_and_b32 v206, 0xffff0000, v206
  v_mul_f32 v55, v55, v206
  v_cvt_pk_bf16_f32 v51, v54, v55
  ds_write_b64 v12, v[44:45] offset:0
  ds_write_b64 v12, v[46:47] offset:544
  ds_write_b64 v12, v[48:49] offset:1088
  ds_write_b64 v12, v[50:51] offset:1632
  v_mul_u32_u24 v2, 272, v8
  v_lshl_add_u32 v2, v1, 4, v2
  v_add_u32 v2, 154880, v2
  v_mov_b32 v2, v2
  v_mov_b32 v9, v4
  v_bfe_u32 v6, v4, 3, 1
  v_lshlrev_b32 v6, 1, v6
  v_and_b32 v7, 1, v1
  v_lshl_add_u32 v6, v7, 2, v6
  v_bfe_u32 v7, v4, 1, 1
  v_or_b32 v6, v6, v7
  v_lshrrev_b32 v7, 2, v4
  v_lshlrev_b32 v7, 7, v7
  v_lshl_add_u32 v7, v1, 10, v7
  v_and_b32 v54, 1, v4
  v_lshl_add_u32 v7, v54, 3, v7
  v_add_u32 v7, 131072, v7
  v_xor_b32 v13, 0, v6
  v_lshl_add_u32 v22, v13, 4, v7
  v_xor_b32 v13, 2, v6
  v_lshl_add_u32 v23, v13, 4, v7
  v_xor_b32 v13, 4, v6
  v_lshl_add_u32 v24, v13, 4, v7
  v_xor_b32 v13, 6, v6
  v_lshl_add_u32 v25, v13, 4, v7
  s_waitcnt lgkmcnt(0)
  ds_read_b128 v[64:67], v2 offset:0
  ds_read_b128 v[68:71], v2 offset:64
  ds_read_b128 v[72:75], v2 offset:128
  ds_read_b128 v[76:79], v2 offset:192
  ds_read_b64_tr_b16 v[96:97], v22 offset:0
  ds_read_b64_tr_b16 v[98:99], v22 offset:512
  ds_read_b64_tr_b16 v[100:101], v22 offset:4096
  ds_read_b64_tr_b16 v[102:103], v22 offset:4608
  ds_read_b64_tr_b16 v[104:105], v22 offset:8192
  ds_read_b64_tr_b16 v[106:107], v22 offset:8704
  ds_read_b64_tr_b16 v[108:109], v22 offset:12288
  ds_read_b64_tr_b16 v[110:111], v22 offset:12800
  ds_read_b64_tr_b16 v[112:113], v23 offset:0
  ds_read_b64_tr_b16 v[114:115], v23 offset:512
  ds_read_b64_tr_b16 v[116:117], v23 offset:4096
  ds_read_b64_tr_b16 v[118:119], v23 offset:4608
  ds_read_b64_tr_b16 v[120:121], v23 offset:8192
  ds_read_b64_tr_b16 v[122:123], v23 offset:8704
  ds_read_b64_tr_b16 v[124:125], v23 offset:12288
  ds_read_b64_tr_b16 v[126:127], v23 offset:12800
  ds_read_b64_tr_b16 v[128:129], v24 offset:0
  ds_read_b64_tr_b16 v[130:131], v24 offset:512
  ds_read_b64_tr_b16 v[132:133], v24 offset:4096
  ds_read_b64_tr_b16 v[134:135], v24 offset:4608
  ds_read_b64_tr_b16 v[136:137], v24 offset:8192
  ds_read_b64_tr_b16 v[138:139], v24 offset:8704
  ds_read_b64_tr_b16 v[140:141], v24 offset:12288
  ds_read_b64_tr_b16 v[142:143], v24 offset:12800
  ds_read_b64_tr_b16 v[144:145], v25 offset:0
  ds_read_b64_tr_b16 v[146:147], v25 offset:512
  ds_read_b64_tr_b16 v[148:149], v25 offset:4096
  ds_read_b64_tr_b16 v[150:151], v25 offset:4608
  ds_read_b64_tr_b16 v[152:153], v25 offset:8192
  ds_read_b64_tr_b16 v[154:155], v25 offset:8704
  ds_read_b64_tr_b16 v[156:157], v25 offset:12288
  ds_read_b64_tr_b16 v[158:159], v25 offset:12800
  v_mul_u32_u24 v9, 3584, v8
  v_lshl_add_u32 v9, v1, 5, v9
  s_mul_i32 s43, s58, 28672
  s_lshl_b32 s47, s59, 9
  s_add_u32 s43, s43, s47
  s_add_u32 s43, s43, 2621440
  v_add_u32 v9, s43, v9
  s_waitcnt lgkmcnt(0)
  v_mfma_f32_16x16x32_bf16 v[160:163], v[96:99], v[64:67], 0
  v_mfma_f32_16x16x32_bf16 v[164:167], v[112:115], v[64:67], 0
  v_mfma_f32_16x16x32_bf16 v[168:171], v[128:131], v[64:67], 0
  v_mfma_f32_16x16x32_bf16 v[172:175], v[144:147], v[64:67], 0
  v_mfma_f32_16x16x32_bf16 v[160:163], v[100:103], v[68:71], v[160:163]
  v_mfma_f32_16x16x32_bf16 v[164:167], v[116:119], v[68:71], v[164:167]
  v_mfma_f32_16x16x32_bf16 v[168:171], v[132:135], v[68:71], v[168:171]
  v_mfma_f32_16x16x32_bf16 v[172:175], v[148:151], v[68:71], v[172:175]
  v_mfma_f32_16x16x32_bf16 v[160:163], v[104:107], v[72:75], v[160:163]
  v_mfma_f32_16x16x32_bf16 v[164:167], v[120:123], v[72:75], v[164:167]
  v_mfma_f32_16x16x32_bf16 v[168:171], v[136:139], v[72:75], v[168:171]
  v_mfma_f32_16x16x32_bf16 v[172:175], v[152:155], v[72:75], v[172:175]
  v_mfma_f32_16x16x32_bf16 v[160:163], v[108:111], v[76:79], v[160:163]
  v_mfma_f32_16x16x32_bf16 v[164:167], v[124:127], v[76:79], v[164:167]
  v_mfma_f32_16x16x32_bf16 v[168:171], v[140:143], v[76:79], v[168:171]
  v_mfma_f32_16x16x32_bf16 v[172:175], v[156:159], v[76:79], v[172:175]
  s_nop 7
  v_mov_b32 v176, v160
  v_mov_b32 v177, s41
  v_mov_b32 v178, v161
  v_mov_b32 v179, s41
  v_mov_b32 v180, v162
  v_mov_b32 v181, s41
  v_mov_b32 v182, v163
  v_mov_b32 v183, s41
  v_mov_b32 v184, v164
  v_mov_b32 v185, s41
  v_mov_b32 v186, v165
  v_mov_b32 v187, s41
  v_mov_b32 v188, v166
  v_mov_b32 v189, s41
  v_mov_b32 v190, v167
  v_mov_b32 v191, s41
  v_mov_b32 v192, v168
  v_mov_b32 v193, s41
  v_mov_b32 v194, v169
  v_mov_b32 v195, s41
  v_mov_b32 v196, v170
  v_mov_b32 v197, s41
  v_mov_b32 v198, v171
  v_mov_b32 v199, s41
  v_mov_b32 v200, v172
  v_mov_b32 v201, s41
  v_mov_b32 v202, v173
  v_mov_b32 v203, s41
  v_mov_b32 v204, v174
  v_mov_b32 v205, s41
  v_mov_b32 v206, v175
  v_mov_b32 v207, s41
  s_mov_b32 s52, 0x00ff00ff
  s_mov_b32 s53, 0x00ff00ff
  s_mov_b64 exec, s[52:53]
  global_store_dwordx4 v9, v[176:179], s[24:25] offset:0 sc1
  global_store_dwordx4 v9, v[180:183], s[24:25] offset:16 sc1
  global_store_dwordx4 v9, v[184:187], s[24:25] offset:128 sc1
  global_store_dwordx4 v9, v[188:191], s[24:25] offset:144 sc1
  global_store_dwordx4 v9, v[192:195], s[24:25] offset:256 sc1
  global_store_dwordx4 v9, v[196:199], s[24:25] offset:272 sc1
  global_store_dwordx4 v9, v[200:203], s[24:25] offset:384 sc1
  global_store_dwordx4 v9, v[204:207], s[24:25] offset:400 sc1
  s_mov_b64 exec, -1
  s_nop 1
L_nojob:
  s_and_b32 s57, s2, 31
  s_mul_i32 s58, s57, 14
  v_min_u32 v4, 13, v4
  v_add_u32 v4, s58, v4
  s_mul_i32 s43, s26, 896
  v_lshl_add_u32 v12, v4, 1, s43
  global_load_ushort v16, v12, s[4:5]
  v_mul_u32_u24 v13, 28672, v1
  v_lshl_add_u32 v13, v4, 3, v13
  s_mul_i32 s43, s26, 3584
  s_add_u32 s43, s43, 2621440
  v_add_u32 v13, s43, v13
  v_add_u32 v22, 114688, v13
  v_add_u32 v23, 229376, v13
  v_add_u32 v24, 344064, v13
  v_mov_b32 v182, 0
  v_mov_b32 v183, s41
  s_mov_b32 s52, -1
  s_mov_b32 s53, 0
  v_mov_b32 v25, v13
L_skipffn:
  v_mul_u32_u24 v13, 28672, v1
  v_lshl_add_u32 v13, v4, 3, v13
  s_mul_i32 s43, s26, 114688
  s_add_u32 s43, s43, 1572864
  v_add_u32 v13, s43, v13
  v_add_u32 v14, 7168, v13
  v_add_u32 v15, 14336, v13
  v_add_u32 v18, 21504, v13
  s_barrier
  v_mov_b32 v182, 0
  v_mov_b32 v183, s41
  s_mov_b32 s52, -1
  s_mov_b32 s53, 0
  s_mov_b32 s50, 262144
L_poll17:
  global_load_dwordx2 v[176:177], v25, s[24:25] sc1
  global_load_dwordx2 v[178:179], v22, s[24:25] sc1
  global_load_dwordx2 v[180:181], v23, s[24:25] sc1
  s_mov_b64 exec, s[52:53]
  global_load_dwordx2 v[182:183], v24, s[24:25] sc1
  s_mov_b64 exec, -1
  s_waitcnt vmcnt(0)
  v_xor_b32 v54, s41, v177
  v_xor_b32 v55, s41, v179
  v_or_b32 v54, v54, v55
  v_xor_b32 v55, s41, v181
  v_or_b32 v54, v54, v55
  v_xor_b32 v55, s41, v183
  v_or_b32 v54, v54, v55
  v_cmp_ne_u32 vcc, 0, v54
  s_cbranch_vccz L_got18
  s_sub_u32 s50, s50, 1
  s_cmp_lg_u32 s50, 0
  s_cbranch_scc1 L_poll17
L_got18:
  v_add_f32 v176, v176, v178
  v_add_f32 v180, v180, v182
  v_add_f32 v176, v176, v180
  v_mov_b32 v55, v176
  s_nop 1
  v_permlane16_swap_b32 v176, v55
  s_nop 0
  v_add_f32 v176, v176, v55
  v_mov_b32 v55, v176
  s_nop 1
  v_permlane32_swap_b32 v176, v55
  s_nop 0
  v_add_f32 v176, v176, v55
  v_cvt_pk_bf16_f32 v176, v176, v176
  v_lshlrev_b32 v176, 16, v176
  v_mul_f32 v54, 0xbfb8aa3b, v176
  v_exp_f32 v54, v54
  s_nop 0
  v_add_f32 v54, 1.0, v54
  v_rcp_f32 v54, v54
  s_nop 0
  v_mul_f32 v17, v176, v54
  v_cvt_pk_bf16_f32 v17, v17, v17
  v_lshlrev_b32 v17, 16, v17
  v_lshlrev_b32 v16, 16, v16
  s_barrier
  s_mov_b32 s50, 262144
L_poll19:
  global_load_dwordx2 v[176:177], v13, s[24:25] sc1
  global_load_dwordx2 v[178:179], v13, s[24:25] offset:3584 sc1
  global_load_dwordx2 v[180:181], v14, s[24:25] sc1
  global_load_dwordx2 v[182:183], v14, s[24:25] offset:3584 sc1
  global_load_dwordx2 v[184:185], v15, s[24:25] sc1
  global_load_dwordx2 v[186:187], v15, s[24:25] offset:3584 sc1
  global_load_dwordx2 v[188:189], v18, s[24:25] sc1
  global_load_dwordx2 v[190:191], v18, s[24:25] offset:3584 sc1
  s_waitcnt vmcnt(0)
  v_xor_b32 v54, s41, v177
  v_xor_b32 v55, s41, v179
  v_or_b32 v54, v54, v55
  v_xor_b32 v55, s41, v181
  v_or_b32 v54, v54, v55
  v_xor_b32 v55, s41, v183
  v_or_b32 v54, v54, v55
  v_xor_b32 v55, s41, v185
  v_or_b32 v54, v54, v55
  v_xor_b32 v55, s41, v187
  v_or_b32 v54, v54, v55
  v_xor_b32 v55, s41, v189
  v_or_b32 v54, v54, v55
  v_xor_b32 v55, s41, v191
  v_or_b32 v54, v54, v55
  v_cmp_ne_u32 vcc, 0, v54
  s_cbranch_vccz L_got20
  s_sub_u32 s50, s50, 1
  s_cmp_lg_u32 s50, 0
  s_cbranch_scc1 L_poll19
L_got20:
  v_add_f32 v176, v176, v178
  v_add_f32 v180, v180, v182
  v_add_f32 v184, v184, v186
  v_add_f32 v188, v188, v190
  v_add_f32 v176, v176, v180
  v_add_f32 v184, v184, v188
  v_add_f32 v176, v176, v184
  v_mov_b32 v55, v176
  s_nop 1
  v_permlane16_swap_b32 v176, v55
  s_nop 0
  v_add_f32 v176, v176, v55
  v_mov_b32 v55, v176
  s_nop 1
  v_permlane32_swap_b32 v176, v55
  s_nop 0
  v_add_f32 v176, v176, v55
  v_cvt_pk_bf16_f32 v176, v176, v176
  v_lshlrev_b32 v176, 16, v176
  v_mul_f32 v176, v176, v17
  v_cvt_pk_bf16_f32 v176, v176, v176
  v_lshlrev_b32 v176, 16, v176
  v_add_f32 v176, v176, v16
  v_cvt_pk_bf16_f32 v176, v176, v176
  s_mov_b64 exec, 0x3fff
  global_store_short v12, v176, s[22:23] sc1
  s_mov_b64 exec, -1
  v_readfirstlane_b32 s43, v19
  s_and_b32 s43, s43, 255
  s_cmp_lg_u32 s43, 255
  s_cbranch_scc1 L_noep21
  v_mov_b32 v1, 0
  v_mov_b32 v2, s41
  s_mov_b64 exec, 1
  global_store_dword v1, v2, s[24:25] offset:0 sc1
  s_mov_b64 exec, -1
L_noep21:
L_end:
  s_endpgm
L_codeend:
.section .rodata,"a"
.p2align 6
.amdhsa_kernel recurrent_scan__gqa_block_cached__swiglu_ffn__decode_kernel
  .amdhsa_next_free_vgpr 256
  .amdhsa_next_free_sgpr 102
  .amdhsa_accum_offset 256
  .amdhsa_group_segment_fixed_size 0
  .amdhsa_kernarg_size 96
  .amdhsa_user_sgpr_count 2
  .amdhsa_user_sgpr_kernarg_segment_ptr 1
  .amdhsa_system_sgpr_workgroup_id_x 1
.end_amdhsa_kernel
```
